```python
import torch

def _softmax(x, axis=-1):
    return torch.softmax(x, dim=axis)
def _gelu(x):
    return torch.nn.functional.gelu(x, approximate="tanh")
def _silu(x):
    return torch.nn.functional.silu(x)
def _sigmoid(x):
    return torch.sigmoid(x)
def _layernorm(x, axis=-1, eps=1e-5):
    m = x.mean(dim=axis, keepdim=True)
    v = x.var(dim=axis, keepdim=True, unbiased=False)
    return (x - m) / torch.sqrt(v + eps)
def _scatter_add(tgt, idx, src, axis=0):
    return tgt.clone().index_add_(axis, idx, src)
def _segment_sum(src, seg, n):
    out = torch.zeros((n,) + src.shape[1:], dtype=src.dtype)
    return out.index_add_(0, seg, src)
def _pad(x, pw):
    flat = tuple(v for pair in reversed(pw) for v in pair)
    return torch.nn.functional.pad(x, flat)

kernel_name = 'standalone__mha_softmax__near_ridge'

def setup_inputs():

    _w = (lambda a: (lambda t: t.to(torch.bfloat16) if t.is_floating_point() else t)(torch.as_tensor(a)))
    B, H, Sq, Sk, D = 8, 32, 288, 2048, 128
    return {
        "q": _w((lambda *s: torch.randn(*s, dtype=torch.bfloat16) * 0.8)(B, H, Sq, D)),
        "k": _w((lambda *s: torch.randn(*s, dtype=torch.bfloat16) * 0.8)(B, H, Sk, D)),
        "v": _w((lambda *s: torch.randn(*s, dtype=torch.bfloat16) * 0.05)(B, H, Sk, D)),
    }

def reference(q, k, v):
    scale = q.shape[-1] ** -0.5
    scores = torch.einsum("bhqd,bhkd->bhqk", q, k) * scale
    p = _softmax(scores, axis=-1)
    return torch.einsum("bhqk,bhkd->bhqd", p, v)
```

```asm
; @launch grid=(256,1,1) block=(256,1,1) lds=163840
.amdgcn_target "amdgcn-amd-amdhsa--gfx950"
.text
.globl standalone__mha_softmax__near_ridge_kernel
.p2align 8
.type standalone__mha_softmax__near_ridge_kernel,@function
standalone__mha_softmax__near_ridge_kernel:
    s_cmp_ge_u32 s2, 256
    s_cbranch_scc1 L_end
    s_load_dwordx4 s[4:7], s[0:1], 0
    s_load_dwordx4 s[8:11], s[0:1], 16
    v_lshrrev_b32 v1, 6, v0
    v_and_b32 v2, 63, v0
    v_and_b32 v5, 15, v0
    v_readfirstlane_b32 s3, v1
    v_lshrrev_b32 v6, 4, v2
    s_getpc_b64 s[52:53]
L_pc:
    s_mov_b32 s54, L_end-L_pc
    s_mov_b32 s55, 0x20000
    v_lshlrev_b32 v254, 7, v0
    s_mov_b32 s35, 32768
    buffer_load_dword v255, v254, s[52:55], 0 offen
    buffer_load_dword v255, v254, s[52:55], s35 offen
    v_add_u32 v244, 0, v6
    v_xor_b32 v244, v244, v5
    v_lshlrev_b32 v244, 4, v244
    v_lshl_add_u32 v208, v6, 8, v244
    v_add_u32 v244, 4, v6
    v_xor_b32 v244, v244, v5
    v_lshlrev_b32 v244, 4, v244
    v_lshl_add_u32 v209, v6, 8, v244
    v_add_u32 v244, 8, v6
    v_xor_b32 v244, v244, v5
    v_lshlrev_b32 v244, 4, v244
    v_lshl_add_u32 v210, v6, 8, v244
    v_add_u32 v244, 12, v6
    v_xor_b32 v244, v244, v5
    v_lshlrev_b32 v244, 4, v244
    v_lshl_add_u32 v211, v6, 8, v244
    v_lshl_add_u32 v7, v1, 3, v6
    v_and_b32 v244, 15, v7
    v_xor_b32 v244, v5, v244
    v_lshlrev_b32 v244, 4, v244
    v_lshl_add_u32 v240, v7, 8, v244
    v_xor_b32 v241, 64, v240
    s_lshl_b32 s30, s3, 11
    s_mov_b32 s33, 0
    s_mov_b32 s34, 0x3e0293ee
    s_lshl_b32 s28, s2, 19
    s_lshr_b32 s29, s2, 13
    s_mul_i32 s36, s2, 73728
    s_lshl_b32 s46, s3, 13
    s_add_u32 s44, s46, 98304
    s_add_u32 s45, s46, 40960
    s_cmp_eq_u32 s3, 3
    s_cselect_b32 s45, 131072, s45
    s_lshl_b32 s46, s3, 14
    s_waitcnt lgkmcnt(0)
    s_add_u32 s20, s4, s36
    s_addc_u32 s21, s5, 0
    s_mov_b32 s22, 73728
    s_mov_b32 s23, 0x20000
    s_add_u32 s12, s6, s28
    s_addc_u32 s13, s7, s29
    s_mov_b32 s14, 524288
    s_mov_b32 s15, 0x20000
    s_add_u32 m0, s44, 0
    s_add_u32 s35, s46, 0
    buffer_load_dwordx4 v208, s[20:23], s35 offen offset:0 nt lds
    buffer_load_dwordx4 v209, s[20:23], s35 offen offset:1024 nt lds
    buffer_load_dwordx4 v210, s[20:23], s35 offen offset:2048 nt lds
    buffer_load_dwordx4 v211, s[20:23], s35 offen offset:3072 nt lds
    s_add_u32 m0, s44, 4096
    s_add_u32 s35, s46, 4096
    buffer_load_dwordx4 v208, s[20:23], s35 offen offset:0 nt lds
    buffer_load_dwordx4 v209, s[20:23], s35 offen offset:1024 nt lds
    buffer_load_dwordx4 v210, s[20:23], s35 offen offset:2048 nt lds
    buffer_load_dwordx4 v211, s[20:23], s35 offen offset:3072 nt lds
    s_add_u32 m0, s30, 0
    s_mov_b32 s35, 0
    buffer_load_dwordx4 v240, s[12:15], s35 offen nt lds
    buffer_load_dwordx4 v241, s[12:15], s35 offen offset:1024 nt lds
    s_add_u32 m0, s30, 139264
    s_mov_b32 s35, 65536
    buffer_load_dwordx4 v240, s[20:23], s35 offen nt lds
    buffer_load_dwordx4 v241, s[20:23], s35 offen offset:1024 nt lds
    s_add_u32 s16, s8, s28
    s_addc_u32 s17, s9, s29
    s_mov_b32 s18, 524288
    s_mov_b32 s19, 0x20000
    s_add_u32 s24, s10, s36
    s_addc_u32 s25, s11, 0
    s_mov_b32 s26, 73728
    s_mov_b32 s27, 0x20000
    s_mov_b32 s37, 8192
    s_mov_b32 s38, 4096
    s_mov_b32 s47, 12288
    s_mov_b32 s40, 0x76800000
    s_mov_b32 s31, 32768
    s_mov_b32 s32, 40960
    v_lshlrev_b32 v244, 2, v6
    v_xor_b32 v244, v5, v244
    v_lshlrev_b32 v244, 4, v244
    v_lshl_add_u32 v242, v7, 8, v244
    v_xor_b32 v243, 32, v242
    v_add_u32 v244, 0, v6
    v_xor_b32 v244, v244, v5
    v_lshlrev_b32 v244, 4, v244
    v_lshl_add_u32 v228, v5, 8, v244
    v_add_u32 v244, 4, v6
    v_xor_b32 v244, v244, v5
    v_lshlrev_b32 v244, 4, v244
    v_lshl_add_u32 v229, v5, 8, v244
    v_add_u32 v244, 8, v6
    v_xor_b32 v244, v244, v5
    v_lshlrev_b32 v244, 4, v244
    v_lshl_add_u32 v230, v5, 8, v244
    v_add_u32 v244, 12, v6
    v_xor_b32 v244, v244, v5
    v_lshlrev_b32 v244, 4, v244
    v_lshl_add_u32 v231, v5, 8, v244
    v_lshrrev_b32 v244, 2, v5
    v_lshl_add_u32 v245, v6, 2, v244
    v_lshlrev_b32 v245, 8, v245
    v_and_b32 v246, 1, v0
    v_lshl_add_u32 v245, v246, 3, v245
    v_bfe_u32 v247, v0, 1, 1
    v_lshl_add_u32 v245, v247, 4, v245
    v_add_u32 v245, 0x10000, v245
    v_and_b32 v248, 1, v6
    v_lshl_or_b32 v249, v244, 1, v248
    v_xor_b32 v250, 0, v249
    v_lshl_add_u32 v232, v250, 5, v245
    v_xor_b32 v250, 1, v249
    v_lshl_add_u32 v233, v250, 5, v245
    v_xor_b32 v250, 2, v249
    v_lshl_add_u32 v234, v250, 5, v245
    v_xor_b32 v250, 3, v249
    v_lshl_add_u32 v235, v250, 5, v245
    v_xor_b32 v250, 4, v249
    v_lshl_add_u32 v236, v250, 5, v245
    v_xor_b32 v250, 5, v249
    v_lshl_add_u32 v237, v250, 5, v245
    v_xor_b32 v250, 6, v249
    v_lshl_add_u32 v238, v250, 5, v245
    v_xor_b32 v250, 7, v249
    v_lshl_add_u32 v239, v250, 5, v245
    s_lshl_b32 s41, s3, 13
    s_add_u32 s41, s41, 90112
    s_cmp_eq_u32 s3, 0
    s_cselect_b32 s41, 40960, s41
    s_cmp_eq_u32 s3, 3
    s_cselect_b32 s41, 131072, s41
    v_lshrrev_b32 v244, 1, v6
    v_lshl_or_b32 v244, v248, 1, v244
    v_lshlrev_b32 v245, 8, v5
    v_add_u32 v246, s41, v245
    v_add_u32 v247, 0, v244
    v_xor_b32 v247, v247, v5
    v_lshl_add_u32 v247, v247, 4, v246
    v_accvgpr_write_b32 a168, v247
    v_add_u32 v247, 4, v244
    v_xor_b32 v247, v247, v5
    v_lshl_add_u32 v247, v247, 4, v246
    v_accvgpr_write_b32 a169, v247
    v_add_u32 v247, 8, v244
    v_xor_b32 v247, v247, v5
    v_lshl_add_u32 v247, v247, 4, v246
    v_accvgpr_write_b32 a170, v247
    v_add_u32 v247, 12, v244
    v_xor_b32 v247, v247, v5
    v_lshl_add_u32 v247, v247, 4, v246
    v_accvgpr_write_b32 a171, v247
    v_add_u32 v247, s46, v208
    v_add_u32 v247, 0, v247
    v_accvgpr_write_b32 a172, v247
    v_add_u32 v247, s46, v209
    v_add_u32 v247, 1024, v247
    v_accvgpr_write_b32 a173, v247
    v_add_u32 v247, s46, v210
    v_add_u32 v247, 2048, v247
    v_accvgpr_write_b32 a174, v247
    v_add_u32 v247, s46, v211
    v_add_u32 v247, 3072, v247
    v_accvgpr_write_b32 a175, v247
    v_lshlrev_b32 v247, 4, v2
    v_add_u32 v246, s41, v247
    v_accvgpr_write_b32 a176, v246
    s_mul_i32 s42, s3, 4352
    s_add_u32 s42, s42, 139264
    s_xor_b32 s43, s3, 1
    s_mul_i32 s43, s43, 4352
    s_add_u32 s43, s43, 139264
    v_add_u32 v246, s42, v247
    v_accvgpr_write_b32 a177, v246
    v_add_u32 v246, s43, v247
    v_accvgpr_write_b32 a178, v246
    s_lshr_b32 s42, s3, 1
    s_lshl_b32 s42, s42, 12
    s_and_b32 s43, s3, 1
    s_lshl_b32 s43, s43, 7
    s_add_u32 s43, s43, s42
    s_add_u32 s43, s43, 65536
    v_lshl_add_u32 v246, v244, 4, v245
    v_add_u32 v246, s43, v246
    v_accvgpr_write_b32 a179, v246
    s_add_u32 s42, s42, 139264
    v_mov_b32 v246, 0x3f803f80
    v_cmp_eq_u32 vcc, 0, v5
    s_nop 1
    v_cndmask_b32 v246, 0, v246, vcc
    v_accvgpr_write_b32 a144, v246
    v_accvgpr_write_b32 a145, v246
    v_accvgpr_write_b32 a146, v246
    v_accvgpr_write_b32 a147, v246
    v_accvgpr_write_b32 a112, 0
    v_accvgpr_write_b32 a113, 0
    v_accvgpr_write_b32 a114, 0
    v_accvgpr_write_b32 a115, 0
    v_accvgpr_write_b32 a116, 0
    v_accvgpr_write_b32 a117, 0
    v_accvgpr_write_b32 a118, 0
    v_accvgpr_write_b32 a119, 0
    v_accvgpr_write_b32 a120, 0
    v_accvgpr_write_b32 a121, 0
    v_accvgpr_write_b32 a122, 0
    v_accvgpr_write_b32 a123, 0
    v_accvgpr_write_b32 a124, 0
    v_accvgpr_write_b32 a125, 0
    v_accvgpr_write_b32 a126, 0
    v_accvgpr_write_b32 a127, 0
    v_accvgpr_write_b32 a128, 0
    v_accvgpr_write_b32 a129, 0
    v_accvgpr_write_b32 a130, 0
    v_accvgpr_write_b32 a131, 0
    v_accvgpr_write_b32 a132, 0
    v_accvgpr_write_b32 a133, 0
    v_accvgpr_write_b32 a134, 0
    v_accvgpr_write_b32 a135, 0
    v_accvgpr_write_b32 a136, 0
    v_accvgpr_write_b32 a137, 0
    v_accvgpr_write_b32 a138, 0
    v_accvgpr_write_b32 a139, 0
    v_accvgpr_write_b32 a140, 0
    v_accvgpr_write_b32 a141, 0
    v_accvgpr_write_b32 a142, 0
    v_accvgpr_write_b32 a143, 0
    v_accvgpr_write_b32 a148, 0
    v_accvgpr_write_b32 a149, 0
    v_accvgpr_write_b32 a150, 0
    v_accvgpr_write_b32 a151, 0
    v_accvgpr_write_b32 a152, 0
    v_accvgpr_write_b32 a153, 0
    v_accvgpr_write_b32 a154, 0
    v_accvgpr_write_b32 a155, 0
    v_accvgpr_write_b32 a156, 0
    v_accvgpr_write_b32 a157, 0
    v_accvgpr_write_b32 a158, 0
    v_accvgpr_write_b32 a159, 0
    v_accvgpr_write_b32 a160, 0
    v_accvgpr_write_b32 a161, 0
    v_accvgpr_write_b32 a162, 0
    v_accvgpr_write_b32 a163, 0
    v_accvgpr_write_b32 a164, 0
    v_accvgpr_write_b32 a165, 0
    v_accvgpr_write_b32 a166, 0
    v_accvgpr_write_b32 a167, 0
    v_mov_b32 v8, 0
    v_mov_b32 v9, 0
    v_mov_b32 v10, 0
    v_mov_b32 v11, 0
    v_mov_b32 v12, 0
    v_mov_b32 v13, 0
    v_mov_b32 v14, 0
    v_mov_b32 v15, 0
    v_mov_b32 v16, 0
    v_mov_b32 v17, 0
    v_mov_b32 v18, 0
    v_mov_b32 v19, 0
    v_mov_b32 v20, 0
    v_mov_b32 v21, 0
    v_mov_b32 v22, 0
    v_mov_b32 v23, 0
    v_mov_b32 v24, 0
    v_mov_b32 v25, 0
    v_mov_b32 v26, 0
    v_mov_b32 v27, 0
    v_mov_b32 v28, 0
    v_mov_b32 v29, 0
    v_mov_b32 v30, 0
    v_mov_b32 v31, 0
    v_mov_b32 v32, 0
    v_mov_b32 v33, 0
    v_mov_b32 v34, 0
    v_mov_b32 v35, 0
    v_mov_b32 v36, 0
    v_mov_b32 v37, 0
    v_mov_b32 v38, 0
    v_mov_b32 v39, 0
    v_mov_b32 v40, 0
    v_mov_b32 v41, 0
    v_mov_b32 v42, 0
    v_mov_b32 v43, 0
    v_mov_b32 v44, 0
    v_mov_b32 v45, 0
    v_mov_b32 v46, 0
    v_mov_b32 v47, 0
    v_mov_b32 v48, 0
    v_mov_b32 v49, 0
    v_mov_b32 v50, 0
    v_mov_b32 v51, 0
    v_mov_b32 v52, 0
    v_mov_b32 v53, 0
    v_mov_b32 v54, 0
    v_mov_b32 v55, 0
    v_mov_b32 v56, 0
    v_mov_b32 v57, 0
    v_mov_b32 v58, 0
    v_mov_b32 v59, 0
    v_mov_b32 v60, 0
    v_mov_b32 v61, 0
    v_mov_b32 v62, 0
    v_mov_b32 v63, 0
    v_mov_b32 v64, 0
    v_mov_b32 v65, 0
    v_mov_b32 v66, 0
    v_mov_b32 v67, 0
    v_mov_b32 v68, 0
    v_mov_b32 v69, 0
    v_mov_b32 v70, 0
    v_mov_b32 v71, 0
    s_add_u32 m0, s45, 0
    s_add_u32 s35, s46, 8192
    buffer_load_dwordx4 v208, s[20:23], s35 offen offset:0 nt lds
    buffer_load_dwordx4 v209, s[20:23], s35 offen offset:1024 nt lds
    buffer_load_dwordx4 v210, s[20:23], s35 offen offset:2048 nt lds
    buffer_load_dwordx4 v211, s[20:23], s35 offen offset:3072 nt lds
    s_add_u32 m0, s45, 4096
    s_add_u32 s35, s46, 12288
    buffer_load_dwordx4 v208, s[20:23], s35 offen offset:0 nt lds
    buffer_load_dwordx4 v209, s[20:23], s35 offen offset:1024 nt lds
    buffer_load_dwordx4 v210, s[20:23], s35 offen offset:2048 nt lds
    buffer_load_dwordx4 v211, s[20:23], s35 offen offset:3072 nt lds
    v_mov_b32 v72, 0
    v_mov_b32 v73, 0
    v_mov_b32 v74, 0
    v_mov_b32 v75, 0
    v_mov_b32 v76, 0
    v_mov_b32 v77, 0
    v_mov_b32 v78, 0
    v_mov_b32 v79, 0
    v_mov_b32 v80, 0
    v_mov_b32 v81, 0
    v_mov_b32 v82, 0
    v_mov_b32 v83, 0
    v_mov_b32 v84, 0
    v_mov_b32 v85, 0
    v_mov_b32 v86, 0
    v_mov_b32 v87, 0
    v_mov_b32 v88, 0
    v_mov_b32 v89, 0
    v_mov_b32 v90, 0
    v_mov_b32 v91, 0
    v_mov_b32 v92, 0
    v_mov_b32 v93, 0
    v_mov_b32 v94, 0
    v_mov_b32 v95, 0
    v_mov_b32 v96, 0
    v_mov_b32 v97, 0
    v_mov_b32 v98, 0
    v_mov_b32 v99, 0
    v_mov_b32 v100, 0
    v_mov_b32 v101, 0
    v_mov_b32 v102, 0
    v_mov_b32 v103, 0
    v_mov_b32 v104, 0
    v_mov_b32 v105, 0
    v_mov_b32 v106, 0
    v_mov_b32 v107, 0
    v_mov_b32 v108, 0
    v_mov_b32 v109, 0
    v_mov_b32 v110, 0
    v_mov_b32 v111, 0
    v_mov_b32 v112, 0
    v_mov_b32 v113, 0
    v_mov_b32 v114, 0
    v_mov_b32 v115, 0
    v_mov_b32 v116, 0
    v_mov_b32 v117, 0
    v_mov_b32 v118, 0
    v_mov_b32 v119, 0
    v_mov_b32 v120, 0
    v_mov_b32 v121, 0
    v_mov_b32 v122, 0
    v_mov_b32 v123, 0
    v_mov_b32 v124, 0
    v_mov_b32 v125, 0
    v_mov_b32 v126, 0
    v_mov_b32 v127, 0
    v_mov_b32 v128, 0
    v_mov_b32 v129, 0
    v_mov_b32 v130, 0
    v_mov_b32 v131, 0
    v_mov_b32 v132, 0
    v_mov_b32 v133, 0
    v_mov_b32 v134, 0
    v_mov_b32 v135, 0
    v_add_u32 v216, s44, v228
    v_add_u32 v220, s45, v228
    v_add_u32 v224, s42, v228
    v_add_u32 v217, s44, v229
    v_add_u32 v221, s45, v229
    v_add_u32 v225, s42, v229
    v_add_u32 v218, s44, v230
    v_add_u32 v222, s45, v230
    v_add_u32 v226, s42, v230
    v_add_u32 v219, s44, v231
    v_add_u32 v223, s45, v231
    v_add_u32 v227, s42, v231
    s_waitcnt vmcnt(12)
    ds_read_b128 v[168:171], v216 offset:0
    ds_read_b128 v[172:175], v217 offset:0
    ds_read_b128 v[176:179], v218 offset:0
    ds_read_b128 v[180:183], v219 offset:0
    ds_read_b128 v[184:187], v216 offset:4096
    ds_read_b128 v[188:191], v217 offset:4096
    ds_read_b128 v[192:195], v218 offset:4096
    ds_read_b128 v[196:199], v219 offset:4096
    s_waitcnt lgkmcnt(7)
    v_lshlrev_b32 v244, 16, v168
    v_and_b32 v245, 0xffff0000, v168
    v_mul_f32 v244, s34, v244
    v_mul_f32 v245, s34, v245
    v_cvt_pk_bf16_f32 v168, v244, v245
    v_accvgpr_write_b32 a0, v168
    v_lshlrev_b32 v246, 16, v169
    v_and_b32 v247, 0xffff0000, v169
    v_mul_f32 v246, s34, v246
    v_mul_f32 v247, s34, v247
    v_cvt_pk_bf16_f32 v169, v246, v247
    v_accvgpr_write_b32 a1, v169
    v_lshlrev_b32 v248, 16, v170
    v_and_b32 v249, 0xffff0000, v170
    v_mul_f32 v248, s34, v248
    v_mul_f32 v249, s34, v249
    v_cvt_pk_bf16_f32 v170, v248, v249
    v_accvgpr_write_b32 a2, v170
    v_lshlrev_b32 v250, 16, v171
    v_and_b32 v251, 0xffff0000, v171
    v_mul_f32 v250, s34, v250
    v_mul_f32 v251, s34, v251
    v_cvt_pk_bf16_f32 v171, v250, v251
    v_accvgpr_write_b32 a3, v171
    s_waitcnt lgkmcnt(6)
    v_lshlrev_b32 v244, 16, v172
    v_and_b32 v245, 0xffff0000, v172
    v_mul_f32 v244, s34, v244
    v_mul_f32 v245, s34, v245
    v_cvt_pk_bf16_f32 v172, v244, v245
    v_accvgpr_write_b32 a4, v172
    v_lshlrev_b32 v246, 16, v173
    v_and_b32 v247, 0xffff0000, v173
    v_mul_f32 v246, s34, v246
    v_mul_f32 v247, s34, v247
    v_cvt_pk_bf16_f32 v173, v246, v247
    v_accvgpr_write_b32 a5, v173
    v_lshlrev_b32 v248, 16, v174
    v_and_b32 v249, 0xffff0000, v174
    v_mul_f32 v248, s34, v248
    v_mul_f32 v249, s34, v249
    v_cvt_pk_bf16_f32 v174, v248, v249
    v_accvgpr_write_b32 a6, v174
    v_lshlrev_b32 v250, 16, v175
    v_and_b32 v251, 0xffff0000, v175
    v_mul_f32 v250, s34, v250
    v_mul_f32 v251, s34, v251
    v_cvt_pk_bf16_f32 v175, v250, v251
    v_accvgpr_write_b32 a7, v175
    s_waitcnt lgkmcnt(5)
    v_lshlrev_b32 v244, 16, v176
    v_and_b32 v245, 0xffff0000, v176
    v_mul_f32 v244, s34, v244
    v_mul_f32 v245, s34, v245
    v_cvt_pk_bf16_f32 v176, v244, v245
    v_accvgpr_write_b32 a8, v176
    v_lshlrev_b32 v246, 16, v177
    v_and_b32 v247, 0xffff0000, v177
    v_mul_f32 v246, s34, v246
    v_mul_f32 v247, s34, v247
    v_cvt_pk_bf16_f32 v177, v246, v247
    v_accvgpr_write_b32 a9, v177
    v_lshlrev_b32 v248, 16, v178
    v_and_b32 v249, 0xffff0000, v178
    v_mul_f32 v248, s34, v248
    v_mul_f32 v249, s34, v249
    v_cvt_pk_bf16_f32 v178, v248, v249
    v_accvgpr_write_b32 a10, v178
    v_lshlrev_b32 v250, 16, v179
    v_and_b32 v251, 0xffff0000, v179
    v_mul_f32 v250, s34, v250
    v_mul_f32 v251, s34, v251
    v_cvt_pk_bf16_f32 v179, v250, v251
    v_accvgpr_write_b32 a11, v179
    s_waitcnt lgkmcnt(4)
    v_lshlrev_b32 v244, 16, v180
    v_and_b32 v245, 0xffff0000, v180
    v_mul_f32 v244, s34, v244
    v_mul_f32 v245, s34, v245
    v_cvt_pk_bf16_f32 v180, v244, v245
    v_accvgpr_write_b32 a12, v180
    v_lshlrev_b32 v246, 16, v181
    v_and_b32 v247, 0xffff0000, v181
    v_mul_f32 v246, s34, v246
    v_mul_f32 v247, s34, v247
    v_cvt_pk_bf16_f32 v181, v246, v247
    v_accvgpr_write_b32 a13, v181
    v_lshlrev_b32 v248, 16, v182
    v_and_b32 v249, 0xffff0000, v182
    v_mul_f32 v248, s34, v248
    v_mul_f32 v249, s34, v249
    v_cvt_pk_bf16_f32 v182, v248, v249
    v_accvgpr_write_b32 a14, v182
    v_lshlrev_b32 v250, 16, v183
    v_and_b32 v251, 0xffff0000, v183
    v_mul_f32 v250, s34, v250
    v_mul_f32 v251, s34, v251
    v_cvt_pk_bf16_f32 v183, v250, v251
    v_accvgpr_write_b32 a15, v183
    s_waitcnt lgkmcnt(3)
    v_lshlrev_b32 v244, 16, v184
    v_and_b32 v245, 0xffff0000, v184
    v_mul_f32 v244, s34, v244
    v_mul_f32 v245, s34, v245
    v_cvt_pk_bf16_f32 v184, v244, v245
    v_accvgpr_write_b32 a16, v184
    v_lshlrev_b32 v246, 16, v185
    v_and_b32 v247, 0xffff0000, v185
    v_mul_f32 v246, s34, v246
    v_mul_f32 v247, s34, v247
    v_cvt_pk_bf16_f32 v185, v246, v247
    v_accvgpr_write_b32 a17, v185
    v_lshlrev_b32 v248, 16, v186
    v_and_b32 v249, 0xffff0000, v186
    v_mul_f32 v248, s34, v248
    v_mul_f32 v249, s34, v249
    v_cvt_pk_bf16_f32 v186, v248, v249
    v_accvgpr_write_b32 a18, v186
    v_lshlrev_b32 v250, 16, v187
    v_and_b32 v251, 0xffff0000, v187
    v_mul_f32 v250, s34, v250
    v_mul_f32 v251, s34, v251
    v_cvt_pk_bf16_f32 v187, v250, v251
    v_accvgpr_write_b32 a19, v187
    s_waitcnt lgkmcnt(2)
    v_lshlrev_b32 v244, 16, v188
    v_and_b32 v245, 0xffff0000, v188
    v_mul_f32 v244, s34, v244
    v_mul_f32 v245, s34, v245
    v_cvt_pk_bf16_f32 v188, v244, v245
    v_accvgpr_write_b32 a20, v188
    v_lshlrev_b32 v246, 16, v189
    v_and_b32 v247, 0xffff0000, v189
    v_mul_f32 v246, s34, v246
    v_mul_f32 v247, s34, v247
    v_cvt_pk_bf16_f32 v189, v246, v247
    v_accvgpr_write_b32 a21, v189
    v_lshlrev_b32 v248, 16, v190
    v_and_b32 v249, 0xffff0000, v190
    v_mul_f32 v248, s34, v248
    v_mul_f32 v249, s34, v249
    v_cvt_pk_bf16_f32 v190, v248, v249
    v_accvgpr_write_b32 a22, v190
    v_lshlrev_b32 v250, 16, v191
    v_and_b32 v251, 0xffff0000, v191
    v_mul_f32 v250, s34, v250
    v_mul_f32 v251, s34, v251
    v_cvt_pk_bf16_f32 v191, v250, v251
    v_accvgpr_write_b32 a23, v191
    s_waitcnt lgkmcnt(1)
    v_lshlrev_b32 v244, 16, v192
    v_and_b32 v245, 0xffff0000, v192
    v_mul_f32 v244, s34, v244
    v_mul_f32 v245, s34, v245
    v_cvt_pk_bf16_f32 v192, v244, v245
    v_accvgpr_write_b32 a24, v192
    v_lshlrev_b32 v246, 16, v193
    v_and_b32 v247, 0xffff0000, v193
    v_mul_f32 v246, s34, v246
    v_mul_f32 v247, s34, v247
    v_cvt_pk_bf16_f32 v193, v246, v247
    v_accvgpr_write_b32 a25, v193
    v_lshlrev_b32 v248, 16, v194
    v_and_b32 v249, 0xffff0000, v194
    v_mul_f32 v248, s34, v248
    v_mul_f32 v249, s34, v249
    v_cvt_pk_bf16_f32 v194, v248, v249
    v_accvgpr_write_b32 a26, v194
    v_lshlrev_b32 v250, 16, v195
    v_and_b32 v251, 0xffff0000, v195
    v_mul_f32 v250, s34, v250
    v_mul_f32 v251, s34, v251
    v_cvt_pk_bf16_f32 v195, v250, v251
    v_accvgpr_write_b32 a27, v195
    s_waitcnt lgkmcnt(0)
    v_lshlrev_b32 v244, 16, v196
    v_and_b32 v245, 0xffff0000, v196
    v_mul_f32 v244, s34, v244
    v_mul_f32 v245, s34, v245
    v_cvt_pk_bf16_f32 v196, v244, v245
    v_accvgpr_write_b32 a28, v196
    v_lshlrev_b32 v246, 16, v197
    v_and_b32 v247, 0xffff0000, v197
    v_mul_f32 v246, s34, v246
    v_mul_f32 v247, s34, v247
    v_cvt_pk_bf16_f32 v197, v246, v247
    v_accvgpr_write_b32 a29, v197
    v_lshlrev_b32 v248, 16, v198
    v_and_b32 v249, 0xffff0000, v198
    v_mul_f32 v248, s34, v248
    v_mul_f32 v249, s34, v249
    v_cvt_pk_bf16_f32 v198, v248, v249
    v_accvgpr_write_b32 a30, v198
    v_lshlrev_b32 v250, 16, v199
    v_and_b32 v251, 0xffff0000, v199
    v_mul_f32 v250, s34, v250
    v_mul_f32 v251, s34, v251
    v_cvt_pk_bf16_f32 v199, v250, v251
    v_accvgpr_write_b32 a31, v199
    s_add_u32 m0, s30, 65536
    s_mov_b32 s35, 0
    buffer_load_dwordx4 v242, s[16:19], s35 offen nt lds
    buffer_load_dwordx4 v243, s[16:19], s35 offen offset:1024 nt lds
    s_add_u32 m0, s30, 8192
    s_mov_b32 s35, 8192
    buffer_load_dwordx4 v240, s[12:15], s35 offen nt lds
    buffer_load_dwordx4 v241, s[12:15], s35 offen offset:1024 nt lds
    s_waitcnt vmcnt(12)
    s_barrier
    ds_read_b128 a[80:83], v228 offset:0
    ds_read_b128 a[84:87], v229 offset:0
    ds_read_b128 a[88:91], v230 offset:0
    ds_read_b128 a[92:95], v231 offset:0
    ds_read_b128 a[96:99], v228 offset:4096
    ds_read_b128 a[100:103], v229 offset:4096
    ds_read_b128 a[104:107], v230 offset:4096
    ds_read_b128 a[108:111], v231 offset:4096
    ds_read_b128 v[184:187], v224
    ds_read_b128 v[188:191], v225
    ds_read_b128 v[192:195], v226
    ds_read_b128 v[196:199], v227
    s_waitcnt lgkmcnt(4)
    v_mfma_f32_16x16x32_bf16 v[168:171], a[80:83], a[0:3], 0
    v_mfma_f32_16x16x32_bf16 v[168:171], a[84:87], a[4:7], v[168:171]
    v_mfma_f32_16x16x32_bf16 v[168:171], a[88:91], a[8:11], v[168:171]
    v_mfma_f32_16x16x32_bf16 v[168:171], a[92:95], a[12:15], v[168:171]
    v_mfma_f32_16x16x32_bf16 v[172:175], a[96:99], a[0:3], 0
    v_mfma_f32_16x16x32_bf16 v[172:175], a[100:103], a[4:7], v[172:175]
    v_mfma_f32_16x16x32_bf16 v[172:175], a[104:107], a[8:11], v[172:175]
    v_mfma_f32_16x16x32_bf16 v[172:175], a[108:111], a[12:15], v[172:175]
    v_mfma_f32_16x16x32_bf16 v[176:179], a[80:83], a[16:19], 0
    v_mfma_f32_16x16x32_bf16 v[176:179], a[84:87], a[20:23], v[176:179]
    v_mfma_f32_16x16x32_bf16 v[176:179], a[88:91], a[24:27], v[176:179]
    v_mfma_f32_16x16x32_bf16 v[176:179], a[92:95], a[28:31], v[176:179]
    v_mfma_f32_16x16x32_bf16 v[180:183], a[96:99], a[16:19], 0
    v_mfma_f32_16x16x32_bf16 v[180:183], a[100:103], a[20:23], v[180:183]
    v_mfma_f32_16x16x32_bf16 v[180:183], a[104:107], a[24:27], v[180:183]
    v_mfma_f32_16x16x32_bf16 v[180:183], a[108:111], a[28:31], v[180:183]
    s_add_u32 m0, s30, 73728
    s_mov_b32 s35, 8192
    buffer_load_dwordx4 v242, s[16:19], s35 offen nt lds
    buffer_load_dwordx4 v243, s[16:19], s35 offen offset:1024 nt lds
    s_add_u32 m0, s30, 16384
    s_mov_b32 s35, 16384
    buffer_load_dwordx4 v240, s[12:15], s35 offen nt lds
    buffer_load_dwordx4 v241, s[12:15], s35 offen offset:1024 nt lds
    s_waitcnt lgkmcnt(0)
    v_lshlrev_b32 v244, 16, v184
    v_and_b32 v245, 0xffff0000, v184
    v_mul_f32 v244, s34, v244
    v_mul_f32 v245, s34, v245
    v_cvt_pk_bf16_f32 v184, v244, v245
    v_accvgpr_write_b32 a64, v184
    v_lshlrev_b32 v246, 16, v185
    v_and_b32 v247, 0xffff0000, v185
    v_mul_f32 v246, s34, v246
    v_mul_f32 v247, s34, v247
    v_cvt_pk_bf16_f32 v185, v246, v247
    v_accvgpr_write_b32 a65, v185
    v_lshlrev_b32 v248, 16, v186
    v_and_b32 v249, 0xffff0000, v186
    v_mul_f32 v248, s34, v248
    v_mul_f32 v249, s34, v249
    v_cvt_pk_bf16_f32 v186, v248, v249
    v_accvgpr_write_b32 a66, v186
    v_lshlrev_b32 v250, 16, v187
    v_and_b32 v251, 0xffff0000, v187
    v_mul_f32 v250, s34, v250
    v_mul_f32 v251, s34, v251
    v_cvt_pk_bf16_f32 v187, v250, v251
    v_accvgpr_write_b32 a67, v187
    v_lshlrev_b32 v244, 16, v188
    v_and_b32 v245, 0xffff0000, v188
    v_mul_f32 v244, s34, v244
    v_mul_f32 v245, s34, v245
    v_cvt_pk_bf16_f32 v188, v244, v245
    v_accvgpr_write_b32 a68, v188
    v_lshlrev_b32 v246, 16, v189
    v_and_b32 v247, 0xffff0000, v189
    v_mul_f32 v246, s34, v246
    v_mul_f32 v247, s34, v247
    v_cvt_pk_bf16_f32 v189, v246, v247
    v_accvgpr_write_b32 a69, v189
    v_lshlrev_b32 v248, 16, v190
    v_and_b32 v249, 0xffff0000, v190
    v_mul_f32 v248, s34, v248
    v_mul_f32 v249, s34, v249
    v_cvt_pk_bf16_f32 v190, v248, v249
    v_accvgpr_write_b32 a70, v190
    v_lshlrev_b32 v250, 16, v191
    v_and_b32 v251, 0xffff0000, v191
    v_mul_f32 v250, s34, v250
    v_mul_f32 v251, s34, v251
    v_cvt_pk_bf16_f32 v191, v250, v251
    v_accvgpr_write_b32 a71, v191
    v_lshlrev_b32 v244, 16, v192
    v_and_b32 v245, 0xffff0000, v192
    v_mul_f32 v244, s34, v244
    v_mul_f32 v245, s34, v245
    v_cvt_pk_bf16_f32 v192, v244, v245
    v_accvgpr_write_b32 a72, v192
    v_lshlrev_b32 v246, 16, v193
    v_and_b32 v247, 0xffff0000, v193
    v_mul_f32 v246, s34, v246
    v_mul_f32 v247, s34, v247
    v_cvt_pk_bf16_f32 v193, v246, v247
    v_accvgpr_write_b32 a73, v193
    v_lshlrev_b32 v248, 16, v194
    v_and_b32 v249, 0xffff0000, v194
    v_mul_f32 v248, s34, v248
    v_mul_f32 v249, s34, v249
    v_cvt_pk_bf16_f32 v194, v248, v249
    v_accvgpr_write_b32 a74, v194
    v_lshlrev_b32 v250, 16, v195
    v_and_b32 v251, 0xffff0000, v195
    v_mul_f32 v250, s34, v250
    v_mul_f32 v251, s34, v251
    v_cvt_pk_bf16_f32 v195, v250, v251
    v_accvgpr_write_b32 a75, v195
    v_lshlrev_b32 v244, 16, v196
    v_and_b32 v245, 0xffff0000, v196
    v_mul_f32 v244, s34, v244
    v_mul_f32 v245, s34, v245
    v_cvt_pk_bf16_f32 v196, v244, v245
    v_accvgpr_write_b32 a76, v196
    v_lshlrev_b32 v246, 16, v197
    v_and_b32 v247, 0xffff0000, v197
    v_mul_f32 v246, s34, v246
    v_mul_f32 v247, s34, v247
    v_cvt_pk_bf16_f32 v197, v246, v247
    v_accvgpr_write_b32 a77, v197
    v_lshlrev_b32 v248, 16, v198
    v_and_b32 v249, 0xffff0000, v198
    v_mul_f32 v248, s34, v248
    v_mul_f32 v249, s34, v249
    v_cvt_pk_bf16_f32 v198, v248, v249
    v_accvgpr_write_b32 a78, v198
    v_lshlrev_b32 v250, 16, v199
    v_and_b32 v251, 0xffff0000, v199
    v_mul_f32 v250, s34, v250
    v_mul_f32 v251, s34, v251
    v_cvt_pk_bf16_f32 v199, v250, v251
    v_accvgpr_write_b32 a79, v199
    s_nop 1
    v_mfma_f32_16x16x32_bf16 v[200:203], a[80:83], a[64:67], 0
    v_mfma_f32_16x16x32_bf16 v[200:203], a[84:87], a[68:71], v[200:203]
    v_mfma_f32_16x16x32_bf16 v[200:203], a[88:91], a[72:75], v[200:203]
    v_mfma_f32_16x16x32_bf16 v[200:203], a[92:95], a[76:79], v[200:203]
    v_mfma_f32_16x16x32_bf16 v[204:207], a[96:99], a[64:67], 0
    v_mfma_f32_16x16x32_bf16 v[204:207], a[100:103], a[68:71], v[204:207]
    v_mfma_f32_16x16x32_bf16 v[204:207], a[104:107], a[72:75], v[204:207]
    v_mfma_f32_16x16x32_bf16 v[204:207], a[108:111], a[76:79], v[204:207]
    v_max3_f32 v3, v168, v169, v170
    v_max3_f32 v3, v3, v171, v172
    v_max3_f32 v3, v3, v173, v174
    v_max_f32 v3, v3, v175
    v_max3_f32 v4, v176, v177, v178
    v_max3_f32 v4, v4, v179, v180
    v_max3_f32 v4, v4, v181, v182
    v_max_f32 v4, v4, v183
    v_mov_b32 v136, 0
    v_mov_b32 v137, 0
    v_mov_b32 v138, 0
    v_mov_b32 v139, 0
    v_mov_b32 v140, 0
    v_mov_b32 v141, 0
    v_mov_b32 v142, 0
    v_mov_b32 v143, 0
    v_mov_b32 v144, 0
    v_mov_b32 v145, 0
    v_mov_b32 v146, 0
    v_mov_b32 v147, 0
    v_mov_b32 v148, 0
    v_mov_b32 v149, 0
    v_mov_b32 v150, 0
    v_mov_b32 v151, 0
    v_mov_b32 v152, 0
    v_mov_b32 v153, 0
    v_mov_b32 v154, 0
    v_mov_b32 v155, 0
    v_mov_b32 v156, 0
    v_mov_b32 v157, 0
    v_mov_b32 v158, 0
    v_mov_b32 v159, 0
    v_mov_b32 v160, 0
    v_mov_b32 v161, 0
    v_mov_b32 v162, 0
    v_mov_b32 v163, 0
    v_mov_b32 v164, 0
    v_mov_b32 v165, 0
    v_mov_b32 v166, 0
    v_mov_b32 v167, 0
    v_max3_f32 v253, v200, v201, v202
    v_max3_f32 v253, v253, v203, v204
    v_max3_f32 v253, v253, v205, v206
    v_max_f32 v253, v253, v207
    s_waitcnt vmcnt(8)
    ds_read_b128 v[168:171], v220 offset:0
    ds_read_b128 v[172:175], v221 offset:0
    ds_read_b128 v[176:179], v222 offset:0
    ds_read_b128 v[180:183], v223 offset:0
    ds_read_b128 v[184:187], v220 offset:4096
    ds_read_b128 v[188:191], v221 offset:4096
    ds_read_b128 v[192:195], v222 offset:4096
    ds_read_b128 v[196:199], v223 offset:4096
    s_add_u32 m0, s30, 81920
    s_mov_b32 s35, 16384
    buffer_load_dwordx4 v242, s[16:19], s35 offen nt lds
    buffer_load_dwordx4 v243, s[16:19], s35 offen offset:1024 nt lds
    s_add_u32 m0, s30, 24576
    s_mov_b32 s35, 24576
    buffer_load_dwordx4 v240, s[12:15], s35 offen nt lds
    buffer_load_dwordx4 v241, s[12:15], s35 offen offset:1024 nt lds
    v_mov_b32 v244, v3
    v_mov_b32 v245, v4
    v_mov_b32 v246, v253
    v_permlane16_swap_b32 v3, v244
    v_permlane16_swap_b32 v4, v245
    v_permlane16_swap_b32 v253, v246
    v_max_f32 v3, v3, v244
    v_max_f32 v4, v4, v245
    v_max_f32 v253, v253, v246
    v_mov_b32 v244, v3
    v_mov_b32 v245, v4
    v_mov_b32 v246, v253
    v_permlane32_swap_b32 v3, v244
    v_permlane32_swap_b32 v4, v245
    v_permlane32_swap_b32 v253, v246
    v_max_f32 v3, v3, v244
    v_max_f32 v4, v4, v245
    v_max_f32 v253, v253, v246
    v_sub_f32 v208, 0xc1800000, v3
    v_sub_f32 v209, 0xc1800000, v3
    v_sub_f32 v210, 0xc1800000, v3
    v_sub_f32 v211, 0xc1800000, v3
    v_sub_f32 v212, 0xc1800000, v4
    v_sub_f32 v213, 0xc1800000, v4
    v_sub_f32 v214, 0xc1800000, v4
    v_sub_f32 v215, 0xc1800000, v4
    v_sub_f32 v224, 0xc1800000, v253
    v_sub_f32 v225, 0xc1800000, v253
    v_sub_f32 v226, 0xc1800000, v253
    v_sub_f32 v227, 0xc1800000, v253
    v_mov_b32 v200, 0xf149f2ca
    v_mov_b32 v201, 0xf149f2ca
    v_mov_b32 v202, 0xf149f2ca
    v_mov_b32 v203, 0xf149f2ca
    v_mov_b32 v204, 0xf149f2ca
    v_mov_b32 v205, 0xf149f2ca
    v_mov_b32 v206, 0xf149f2ca
    v_mov_b32 v207, 0xf149f2ca
    s_mov_b32 s49, 65536
    s_waitcnt lgkmcnt(7)
    v_lshlrev_b32 v244, 16, v168
    v_and_b32 v245, 0xffff0000, v168
    v_mul_f32 v244, s34, v244
    v_mul_f32 v245, s34, v245
    v_cvt_pk_bf16_f32 v168, v244, v245
    v_accvgpr_write_b32 a32, v168
    v_lshlrev_b32 v246, 16, v169
    v_and_b32 v247, 0xffff0000, v169
    v_mul_f32 v246, s34, v246
    v_mul_f32 v247, s34, v247
    v_cvt_pk_bf16_f32 v169, v246, v247
    v_accvgpr_write_b32 a33, v169
    v_lshlrev_b32 v248, 16, v170
    v_and_b32 v249, 0xffff0000, v170
    v_mul_f32 v248, s34, v248
    v_mul_f32 v249, s34, v249
    v_cvt_pk_bf16_f32 v170, v248, v249
    v_accvgpr_write_b32 a34, v170
    v_lshlrev_b32 v250, 16, v171
    v_and_b32 v251, 0xffff0000, v171
    v_mul_f32 v250, s34, v250
    v_mul_f32 v251, s34, v251
    v_cvt_pk_bf16_f32 v171, v250, v251
    v_accvgpr_write_b32 a35, v171
    s_waitcnt lgkmcnt(6)
    v_lshlrev_b32 v244, 16, v172
    v_and_b32 v245, 0xffff0000, v172
    v_mul_f32 v244, s34, v244
    v_mul_f32 v245, s34, v245
    v_cvt_pk_bf16_f32 v172, v244, v245
    v_accvgpr_write_b32 a36, v172
    v_lshlrev_b32 v246, 16, v173
    v_and_b32 v247, 0xffff0000, v173
    v_mul_f32 v246, s34, v246
    v_mul_f32 v247, s34, v247
    v_cvt_pk_bf16_f32 v173, v246, v247
    v_accvgpr_write_b32 a37, v173
    v_lshlrev_b32 v248, 16, v174
    v_and_b32 v249, 0xffff0000, v174
    v_mul_f32 v248, s34, v248
    v_mul_f32 v249, s34, v249
    v_cvt_pk_bf16_f32 v174, v248, v249
    v_accvgpr_write_b32 a38, v174
    v_lshlrev_b32 v250, 16, v175
    v_and_b32 v251, 0xffff0000, v175
    v_mul_f32 v250, s34, v250
    v_mul_f32 v251, s34, v251
    v_cvt_pk_bf16_f32 v175, v250, v251
    v_accvgpr_write_b32 a39, v175
    s_waitcnt lgkmcnt(5)
    v_lshlrev_b32 v244, 16, v176
    v_and_b32 v245, 0xffff0000, v176
    v_mul_f32 v244, s34, v244
    v_mul_f32 v245, s34, v245
    v_cvt_pk_bf16_f32 v176, v244, v245
    v_accvgpr_write_b32 a40, v176
    v_lshlrev_b32 v246, 16, v177
    v_and_b32 v247, 0xffff0000, v177
    v_mul_f32 v246, s34, v246
    v_mul_f32 v247, s34, v247
    v_cvt_pk_bf16_f32 v177, v246, v247
    v_accvgpr_write_b32 a41, v177
    v_lshlrev_b32 v248, 16, v178
    v_and_b32 v249, 0xffff0000, v178
    v_mul_f32 v248, s34, v248
    v_mul_f32 v249, s34, v249
    v_cvt_pk_bf16_f32 v178, v248, v249
    v_accvgpr_write_b32 a42, v178
    v_lshlrev_b32 v250, 16, v179
    v_and_b32 v251, 0xffff0000, v179
    v_mul_f32 v250, s34, v250
    v_mul_f32 v251, s34, v251
    v_cvt_pk_bf16_f32 v179, v250, v251
    v_accvgpr_write_b32 a43, v179
    s_waitcnt lgkmcnt(4)
    v_lshlrev_b32 v244, 16, v180
    v_and_b32 v245, 0xffff0000, v180
    v_mul_f32 v244, s34, v244
    v_mul_f32 v245, s34, v245
    v_cvt_pk_bf16_f32 v180, v244, v245
    v_accvgpr_write_b32 a44, v180
    v_lshlrev_b32 v246, 16, v181
    v_and_b32 v247, 0xffff0000, v181
    v_mul_f32 v246, s34, v246
    v_mul_f32 v247, s34, v247
    v_cvt_pk_bf16_f32 v181, v246, v247
    v_accvgpr_write_b32 a45, v181
    v_lshlrev_b32 v248, 16, v182
    v_and_b32 v249, 0xffff0000, v182
    v_mul_f32 v248, s34, v248
    v_mul_f32 v249, s34, v249
    v_cvt_pk_bf16_f32 v182, v248, v249
    v_accvgpr_write_b32 a46, v182
    v_lshlrev_b32 v250, 16, v183
    v_and_b32 v251, 0xffff0000, v183
    v_mul_f32 v250, s34, v250
    v_mul_f32 v251, s34, v251
    v_cvt_pk_bf16_f32 v183, v250, v251
    v_accvgpr_write_b32 a47, v183
    s_waitcnt lgkmcnt(3)
    v_lshlrev_b32 v244, 16, v184
    v_and_b32 v245, 0xffff0000, v184
    v_mul_f32 v244, s34, v244
    v_mul_f32 v245, s34, v245
    v_cvt_pk_bf16_f32 v184, v244, v245
    v_accvgpr_write_b32 a48, v184
    v_lshlrev_b32 v246, 16, v185
    v_and_b32 v247, 0xffff0000, v185
    v_mul_f32 v246, s34, v246
    v_mul_f32 v247, s34, v247
    v_cvt_pk_bf16_f32 v185, v246, v247
    v_accvgpr_write_b32 a49, v185
    v_lshlrev_b32 v248, 16, v186
    v_and_b32 v249, 0xffff0000, v186
    v_mul_f32 v248, s34, v248
    v_mul_f32 v249, s34, v249
    v_cvt_pk_bf16_f32 v186, v248, v249
    v_accvgpr_write_b32 a50, v186
    v_lshlrev_b32 v250, 16, v187
    v_and_b32 v251, 0xffff0000, v187
    v_mul_f32 v250, s34, v250
    v_mul_f32 v251, s34, v251
    v_cvt_pk_bf16_f32 v187, v250, v251
    v_accvgpr_write_b32 a51, v187
    v_mfma_f32_16x16x32_bf16 v[168:171], a[80:83], a[32:35], 0
    v_mfma_f32_16x16x32_bf16 v[168:171], a[84:87], a[36:39], v[168:171]
    s_waitcnt lgkmcnt(2)
    v_lshlrev_b32 v244, 16, v188
    v_and_b32 v245, 0xffff0000, v188
    v_mul_f32 v244, s34, v244
    v_mul_f32 v245, s34, v245
    v_cvt_pk_bf16_f32 v188, v244, v245
    v_accvgpr_write_b32 a52, v188
    v_lshlrev_b32 v246, 16, v189
    v_and_b32 v247, 0xffff0000, v189
    v_mul_f32 v246, s34, v246
    v_mul_f32 v247, s34, v247
    v_cvt_pk_bf16_f32 v189, v246, v247
    v_accvgpr_write_b32 a53, v189
    v_lshlrev_b32 v248, 16, v190
    v_and_b32 v249, 0xffff0000, v190
    v_mul_f32 v248, s34, v248
    v_mul_f32 v249, s34, v249
    v_cvt_pk_bf16_f32 v190, v248, v249
    v_accvgpr_write_b32 a54, v190
    v_lshlrev_b32 v250, 16, v191
    v_and_b32 v251, 0xffff0000, v191
    v_mul_f32 v250, s34, v250
    v_mul_f32 v251, s34, v251
    v_cvt_pk_bf16_f32 v191, v250, v251
    v_accvgpr_write_b32 a55, v191
    v_mfma_f32_16x16x32_bf16 v[168:171], a[88:91], a[40:43], v[168:171]
    v_mfma_f32_16x16x32_bf16 v[168:171], a[92:95], a[44:47], v[168:171]
    s_waitcnt lgkmcnt(1)
    v_lshlrev_b32 v244, 16, v192
    v_and_b32 v245, 0xffff0000, v192
    v_mul_f32 v244, s34, v244
    v_mul_f32 v245, s34, v245
    v_cvt_pk_bf16_f32 v192, v244, v245
    v_accvgpr_write_b32 a56, v192
    v_lshlrev_b32 v246, 16, v193
    v_and_b32 v247, 0xffff0000, v193
    v_mul_f32 v246, s34, v246
    v_mul_f32 v247, s34, v247
    v_cvt_pk_bf16_f32 v193, v246, v247
    v_accvgpr_write_b32 a57, v193
    v_lshlrev_b32 v248, 16, v194
    v_and_b32 v249, 0xffff0000, v194
    v_mul_f32 v248, s34, v248
    v_mul_f32 v249, s34, v249
    v_cvt_pk_bf16_f32 v194, v248, v249
    v_accvgpr_write_b32 a58, v194
    v_lshlrev_b32 v250, 16, v195
    v_and_b32 v251, 0xffff0000, v195
    v_mul_f32 v250, s34, v250
    v_mul_f32 v251, s34, v251
    v_cvt_pk_bf16_f32 v195, v250, v251
    v_accvgpr_write_b32 a59, v195
    v_mfma_f32_16x16x32_bf16 v[172:175], a[96:99], a[32:35], 0
    v_mfma_f32_16x16x32_bf16 v[172:175], a[100:103], a[36:39], v[172:175]
    s_waitcnt lgkmcnt(0)
    v_lshlrev_b32 v244, 16, v196
    v_and_b32 v245, 0xffff0000, v196
    v_mul_f32 v244, s34, v244
    v_mul_f32 v245, s34, v245
    v_cvt_pk_bf16_f32 v196, v244, v245
    v_accvgpr_write_b32 a60, v196
    v_lshlrev_b32 v246, 16, v197
    v_and_b32 v247, 0xffff0000, v197
    v_mul_f32 v246, s34, v246
    v_mul_f32 v247, s34, v247
    v_cvt_pk_bf16_f32 v197, v246, v247
    v_accvgpr_write_b32 a61, v197
    v_lshlrev_b32 v248, 16, v198
    v_and_b32 v249, 0xffff0000, v198
    v_mul_f32 v248, s34, v248
    v_mul_f32 v249, s34, v249
    v_cvt_pk_bf16_f32 v198, v248, v249
    v_accvgpr_write_b32 a62, v198
    v_lshlrev_b32 v250, 16, v199
    v_and_b32 v251, 0xffff0000, v199
    v_mul_f32 v250, s34, v250
    v_mul_f32 v251, s34, v251
    v_cvt_pk_bf16_f32 v199, v250, v251
    v_accvgpr_write_b32 a63, v199
    v_mfma_f32_16x16x32_bf16 v[172:175], a[104:107], a[40:43], v[172:175]
    v_mfma_f32_16x16x32_bf16 v[172:175], a[108:111], a[44:47], v[172:175]
    s_nop 1
    v_mfma_f32_16x16x32_bf16 v[176:179], a[80:83], a[48:51], 0
    v_mfma_f32_16x16x32_bf16 v[176:179], a[84:87], a[52:55], v[176:179]
    v_mfma_f32_16x16x32_bf16 v[176:179], a[88:91], a[56:59], v[176:179]
    v_mfma_f32_16x16x32_bf16 v[176:179], a[92:95], a[60:63], v[176:179]
    v_mfma_f32_16x16x32_bf16 v[180:183], a[96:99], a[48:51], 0
    v_mfma_f32_16x16x32_bf16 v[180:183], a[100:103], a[52:55], v[180:183]
    v_mfma_f32_16x16x32_bf16 v[180:183], a[104:107], a[56:59], v[180:183]
    v_mfma_f32_16x16x32_bf16 v[180:183], a[108:111], a[60:63], v[180:183]
    s_add_u32 m0, s30, 90112
    s_mov_b32 s35, 24576
    buffer_load_dwordx4 v242, s[16:19], s35 offen nt lds
    buffer_load_dwordx4 v243, s[16:19], s35 offen offset:1024 nt lds
    s_add_u32 m0, s30, 32768
    s_mov_b32 s35, 32768
    buffer_load_dwordx4 v240, s[12:15], s35 offen nt lds
    buffer_load_dwordx4 v241, s[12:15], s35 offen offset:1024 nt lds
    v_max3_f32 v7, v168, v169, v170
    v_max3_f32 v7, v7, v171, v172
    v_max3_f32 v7, v7, v173, v174
    v_max_f32 v7, v7, v175
    v_mov_b32 v184, 0xf149f2ca
    v_mov_b32 v185, 0xf149f2ca
    v_mov_b32 v186, 0xf149f2ca
    v_mov_b32 v187, 0xf149f2ca
    v_mov_b32 v188, 0xf149f2ca
    v_mov_b32 v189, 0xf149f2ca
    v_mov_b32 v190, 0xf149f2ca
    v_mov_b32 v191, 0xf149f2ca
    v_mov_b32 v192, 0xf149f2ca
    v_mov_b32 v193, 0xf149f2ca
    v_mov_b32 v194, 0xf149f2ca
    v_mov_b32 v195, 0xf149f2ca
    v_mov_b32 v196, 0xf149f2ca
    v_mov_b32 v197, 0xf149f2ca
    v_mov_b32 v198, 0xf149f2ca
    v_mov_b32 v199, 0xf149f2ca
    v_max3_f32 v252, v176, v177, v178
    v_max3_f32 v252, v252, v179, v180
    v_max3_f32 v252, v252, v181, v182
    v_max_f32 v252, v252, v183
    v_mov_b32 v244, v7
    v_mov_b32 v245, v252
    s_nop 1
    v_permlane16_swap_b32 v7, v244
    v_permlane16_swap_b32 v252, v245
    v_max_f32 v7, v7, v244
    v_max_f32 v252, v252, v245
    v_mov_b32 v244, v7
    v_mov_b32 v245, v252
    s_nop 1
    v_permlane32_swap_b32 v7, v244
    v_permlane32_swap_b32 v252, v245
    v_max_f32 v7, v7, v244
    v_max_f32 v252, v252, v245
    v_sub_f32 v216, 0xc1800000, v7
    v_sub_f32 v217, 0xc1800000, v7
    v_sub_f32 v218, 0xc1800000, v7
    v_sub_f32 v219, 0xc1800000, v7
    v_sub_f32 v220, 0xc1800000, v252
    v_sub_f32 v221, 0xc1800000, v252
    v_sub_f32 v222, 0xc1800000, v252
    v_sub_f32 v223, 0xc1800000, v252
L_go:
    v_lshlrev_b32 v244, 4, v0
    s_lshl_b32 s51, s3, 10
    s_add_u32 s51, s51, 157696
    s_bitcmp1_b32 s3, 0
    s_cbranch_scc1 L_ver1
    v_exp_f32 v184, v184
    s_nop 0
    v_exp_f32 v185, v185
    s_nop 0
    v_cvt_pk_bf16_f32 v184, v184, v185
    v_exp_f32 v186, v186
    s_nop 0
    v_exp_f32 v187, v187
    s_nop 0
    v_cvt_pk_bf16_f32 v185, v186, v187
    v_exp_f32 v188, v188
    s_nop 0
    v_exp_f32 v189, v189
    s_nop 0
    v_cvt_pk_bf16_f32 v186, v188, v189
    v_exp_f32 v190, v190
    s_nop 0
    v_exp_f32 v191, v191
    s_nop 0
    v_cvt_pk_bf16_f32 v187, v190, v191
    v_exp_f32 v192, v192
    s_nop 0
    v_exp_f32 v193, v193
    s_nop 0
    v_cvt_pk_bf16_f32 v192, v192, v193
    v_exp_f32 v194, v194
    s_nop 0
    s_waitcnt vmcnt(12)
    s_barrier
    v_mfma_f32_16x16x32_bf16 v[168:171], a[80:83], a[0:3], v[208:211]
    s_branch L_in0_0
.p2align 6
L_loop0:
    s_waitcnt lgkmcnt(0)
    v_mfma_f32_16x16x32_bf16 v[168:171], a[80:83], a[0:3], v[208:211]
    s_waitcnt vmcnt(8)
    s_barrier
L_in0_0:
    v_mfma_f32_16x16x32_bf16 v[168:171], a[84:87], a[4:7], v[168:171]
    v_exp_f32 v195, v195
    v_mfma_f32_16x16x32_bf16 v[168:171], a[88:91], a[8:11], v[168:171]
    v_cvt_pk_bf16_f32 v193, v194, v195
    s_add_u32 m0, s30, 98304
    v_mfma_f32_16x16x32_bf16 v[168:171], a[92:95], a[12:15], v[168:171]
    v_exp_f32 v196, v196
    v_mfma_f32_16x16x32_bf16 v[172:175], a[96:99], a[0:3], v[208:211]
    buffer_load_dwordx4 v242, s[16:19], s31 offen nt lds
    v_mfma_f32_16x16x32_bf16 v[172:175], a[100:103], a[4:7], v[172:175]
    v_exp_f32 v197, v197
    v_mfma_f32_16x16x32_bf16 v[172:175], a[104:107], a[8:11], v[172:175]
    buffer_load_dwordx4 v243, s[16:19], s31 offen offset:1024 nt lds
    v_cvt_pk_bf16_f32 v194, v196, v197
    v_mfma_f32_16x16x32_bf16 v[172:175], a[108:111], a[12:15], v[172:175]
    v_exp_f32 v198, v198
    v_mfma_f32_16x16x32_bf16 v[176:179], a[80:83], a[16:19], v[212:215]
    s_add_u32 s31, s31, 16384
    v_mfma_f32_16x16x32_bf16 v[176:179], a[84:87], a[20:23], v[176:179]
    v_exp_f32 v199, v199
    v_mfma_f32_16x16x32_bf16 v[176:179], a[88:91], a[24:27], v[176:179]
    v_cvt_pk_bf16_f32 v195, v198, v199
    v_mfma_f32_16x16x32_bf16 v[176:179], a[92:95], a[28:31], v[176:179]
    v_exp_f32 v168, v168
    v_mfma_f32_16x16x32_bf16 v[180:183], a[96:99], a[16:19], v[212:215]
    s_cmp_lt_u32 s49, 90112
    s_cbranch_scc1 L_pf0_0_0
L_pf0_0_0r:
    v_mfma_f32_16x16x32_bf16 v[180:183], a[100:103], a[20:23], v[180:183]
    v_exp_f32 v169, v169
    v_mfma_f32_16x16x32_bf16 v[180:183], a[104:107], a[24:27], v[180:183]
    v_cvt_pk_bf16_f32 v168, v168, v169
    v_mfma_f32_16x16x32_bf16 v[180:183], a[108:111], a[28:31], v[180:183]
    v_exp_f32 v170, v170
    v_mfma_f32_16x16x32_bf16 v[72:75], a[112:115], v[184:187], v[72:75]
    v_mfma_f32_16x16x32_bf16 v[104:107], a[112:115], v[192:195], v[104:107]
    v_exp_f32 v171, v171
    v_mfma_f32_16x16x32_bf16 v[76:79], a[116:119], v[184:187], v[76:79]
    ds_read_b64_tr_b16 a[112:113], v232 offset:0
    v_cvt_pk_bf16_f32 v169, v170, v171
    v_mfma_f32_16x16x32_bf16 v[108:111], a[116:119], v[192:195], v[108:111]
    v_exp_f32 v172, v172
    v_mfma_f32_16x16x32_bf16 v[80:83], a[120:123], v[184:187], v[80:83]
    ds_read_b64_tr_b16 a[114:115], v232 offset:4096
    v_mfma_f32_16x16x32_bf16 v[112:115], a[120:123], v[192:195], v[112:115]
    v_exp_f32 v173, v173
    v_mfma_f32_16x16x32_bf16 v[84:87], a[124:127], v[184:187], v[84:87]
    ds_read_b64_tr_b16 a[116:117], v233 offset:0
    v_cvt_pk_bf16_f32 v170, v172, v173
    v_mfma_f32_16x16x32_bf16 v[116:119], a[124:127], v[192:195], v[116:119]
    v_exp_f32 v174, v174
    v_mfma_f32_16x16x32_bf16 v[88:91], a[128:131], v[184:187], v[88:91]
    ds_read_b64_tr_b16 a[118:119], v233 offset:4096
    v_mfma_f32_16x16x32_bf16 v[120:123], a[128:131], v[192:195], v[120:123]
    v_exp_f32 v175, v175
    v_mfma_f32_16x16x32_bf16 v[92:95], a[132:135], v[184:187], v[92:95]
    v_cvt_pk_bf16_f32 v171, v174, v175
    v_mfma_f32_16x16x32_bf16 v[124:127], a[132:135], v[192:195], v[124:127]
    ds_read_b64_tr_b16 a[120:121], v234 offset:0
    v_mfma_f32_16x16x32_bf16 v[96:99], a[136:139], v[184:187], v[96:99]
    v_exp_f32 v176, v176
    v_mfma_f32_16x16x32_bf16 v[128:131], a[136:139], v[192:195], v[128:131]
    ds_read_b64_tr_b16 a[122:123], v234 offset:4096
    v_mfma_f32_16x16x32_bf16 v[100:103], a[140:143], v[184:187], v[100:103]
    v_exp_f32 v177, v177
    v_mfma_f32_16x16x32_bf16 v[132:135], a[140:143], v[192:195], v[132:135]
    ds_read_b64_tr_b16 a[124:125], v235 offset:0
    v_cvt_pk_bf16_f32 v176, v176, v177
    v_mfma_f32_16x16x32_bf16 a[156:159], a[144:147], v[184:187], a[156:159]
    v_exp_f32 v178, v178
    v_mfma_f32_16x16x32_bf16 a[160:163], a[144:147], v[192:195], a[160:163]
    ds_read_b64_tr_b16 a[126:127], v235 offset:4096
    v_mfma_f32_16x16x32_bf16 v[200:203], a[80:83], a[64:67], v[224:227]
    v_exp_f32 v179, v179
    v_mfma_f32_16x16x32_bf16 v[200:203], a[84:87], a[68:71], v[200:203]
    ds_read_b64_tr_b16 a[128:129], v236 offset:0
    v_cvt_pk_bf16_f32 v177, v178, v179
    v_mfma_f32_16x16x32_bf16 v[200:203], a[88:91], a[72:75], v[200:203]
    v_exp_f32 v180, v180
    v_mfma_f32_16x16x32_bf16 v[200:203], a[92:95], a[76:79], v[200:203]
    ds_read_b64_tr_b16 a[130:131], v236 offset:4096
    v_mfma_f32_16x16x32_bf16 v[204:207], a[96:99], a[64:67], v[224:227]
    v_exp_f32 v181, v181
    v_mfma_f32_16x16x32_bf16 v[204:207], a[100:103], a[68:71], v[204:207]
    ds_read_b64_tr_b16 a[132:133], v237 offset:0
    v_cvt_pk_bf16_f32 v178, v180, v181
    v_mfma_f32_16x16x32_bf16 v[204:207], a[104:107], a[72:75], v[204:207]
    v_exp_f32 v182, v182
    v_mfma_f32_16x16x32_bf16 v[204:207], a[108:111], a[76:79], v[204:207]
    ds_read_b64_tr_b16 a[134:135], v237 offset:4096
    v_mfma_f32_16x16x32_bf16 v[184:187], a[80:83], a[32:35], v[216:219]
    v_exp_f32 v183, v183
    v_mfma_f32_16x16x32_bf16 v[184:187], a[84:87], a[36:39], v[184:187]
    v_cvt_pk_bf16_f32 v179, v182, v183
    s_add_u32 m0, s30, 40960
    v_mfma_f32_16x16x32_bf16 v[184:187], a[88:91], a[40:43], v[184:187]
    buffer_load_dwordx4 v240, s[12:15], s32 offen nt lds
    ds_read_b64_tr_b16 a[136:137], v238 offset:0
    v_mfma_f32_16x16x32_bf16 v[184:187], a[92:95], a[44:47], v[184:187]
    v_exp_f32 v200, v200
    v_mfma_f32_16x16x32_bf16 v[188:191], a[96:99], a[32:35], v[216:219]
    buffer_load_dwordx4 v241, s[12:15], s32 offen offset:1024 nt lds
    ds_read_b64_tr_b16 a[138:139], v238 offset:4096
    v_mfma_f32_16x16x32_bf16 v[188:191], a[100:103], a[36:39], v[188:191]
    v_exp_f32 v201, v201
    v_mfma_f32_16x16x32_bf16 v[188:191], a[104:107], a[40:43], v[188:191]
    ds_read_b64_tr_b16 a[140:141], v239 offset:0
    v_cvt_pk_bf16_f32 v200, v200, v201
    v_mfma_f32_16x16x32_bf16 v[188:191], a[108:111], a[44:47], v[188:191]
    v_exp_f32 v202, v202
    v_mfma_f32_16x16x32_bf16 v[192:195], a[80:83], a[48:51], v[220:223]
    ds_read_b64_tr_b16 a[142:143], v239 offset:4096
    v_mfma_f32_16x16x32_bf16 v[192:195], a[84:87], a[52:55], v[192:195]
    v_exp_f32 v203, v203
    v_mfma_f32_16x16x32_bf16 v[192:195], a[88:91], a[56:59], v[192:195]
    ds_read_b128 a[80:83], v228 offset:8192
    v_cvt_pk_bf16_f32 v201, v202, v203
    v_mfma_f32_16x16x32_bf16 v[192:195], a[92:95], a[60:63], v[192:195]
    v_exp_f32 v184, v184
    v_mfma_f32_16x16x32_bf16 v[196:199], a[96:99], a[48:51], v[220:223]
    ds_read_b128 a[84:87], v229 offset:8192
    v_mfma_f32_16x16x32_bf16 v[196:199], a[100:103], a[52:55], v[196:199]
    v_exp_f32 v185, v185
    v_mfma_f32_16x16x32_bf16 v[196:199], a[104:107], a[56:59], v[196:199]
    v_cvt_pk_bf16_f32 v184, v184, v185
    v_mfma_f32_16x16x32_bf16 v[196:199], a[108:111], a[60:63], v[196:199]
    ds_read_b128 a[88:91], v230 offset:8192
    s_waitcnt lgkmcnt(3)
    v_mfma_f32_16x16x32_bf16 v[8:11], a[112:115], v[168:171], v[8:11]
    v_exp_f32 v186, v186
    v_mfma_f32_16x16x32_bf16 v[12:15], a[116:119], v[168:171], v[12:15]
    ds_read_b128 a[92:95], v231 offset:8192
    v_mfma_f32_16x16x32_bf16 v[16:19], a[120:123], v[168:171], v[16:19]
    v_exp_f32 v187, v187
    v_mfma_f32_16x16x32_bf16 v[20:23], a[124:127], v[168:171], v[20:23]
    ds_read_b128 a[96:99], v228 offset:12288
    v_cvt_pk_bf16_f32 v185, v186, v187
    v_mfma_f32_16x16x32_bf16 v[24:27], a[128:131], v[168:171], v[24:27]
    v_exp_f32 v188, v188
    v_mfma_f32_16x16x32_bf16 v[28:31], a[132:135], v[168:171], v[28:31]
    ds_read_b128 a[100:103], v229 offset:12288
    v_mfma_f32_16x16x32_bf16 v[32:35], a[136:139], v[168:171], v[32:35]
    v_exp_f32 v189, v189
    v_mfma_f32_16x16x32_bf16 v[36:39], a[140:143], v[168:171], v[36:39]
    ds_read_b128 a[104:107], v230 offset:12288
    v_cvt_pk_bf16_f32 v186, v188, v189
    v_mfma_f32_16x16x32_bf16 a[148:151], a[144:147], v[168:171], a[148:151]
    v_exp_f32 v190, v190
    v_mfma_f32_16x16x32_bf16 v[40:43], a[112:115], v[176:179], v[40:43]
    ds_read_b128 a[108:111], v231 offset:12288
    v_mfma_f32_16x16x32_bf16 v[44:47], a[116:119], v[176:179], v[44:47]
    v_exp_f32 v191, v191
    v_mfma_f32_16x16x32_bf16 v[48:51], a[120:123], v[176:179], v[48:51]
    v_cvt_pk_bf16_f32 v187, v190, v191
    v_mfma_f32_16x16x32_bf16 v[52:55], a[124:127], v[176:179], v[52:55]
    v_exp_f32 v204, v204
    v_mfma_f32_16x16x32_bf16 v[56:59], a[128:131], v[176:179], v[56:59]
    s_cmp_lt_u32 s49, 90112
    s_cbranch_scc1 L_pf0_1_0
L_pf0_1_0r:
    v_mfma_f32_16x16x32_bf16 v[60:63], a[132:135], v[176:179], v[60:63]
    v_exp_f32 v205, v205
    v_mfma_f32_16x16x32_bf16 v[64:67], a[136:139], v[176:179], v[64:67]
    v_cvt_pk_bf16_f32 v202, v204, v205
    v_mfma_f32_16x16x32_bf16 v[68:71], a[140:143], v[176:179], v[68:71]
    v_exp_f32 v206, v206
    v_mfma_f32_16x16x32_bf16 a[152:155], a[144:147], v[176:179], a[152:155]
    s_waitcnt lgkmcnt(0)
    v_mfma_f32_16x16x32_bf16 v[168:171], a[80:83], a[0:3], v[208:211]
    v_exp_f32 v207, v207
    v_mfma_f32_16x16x32_bf16 v[168:171], a[84:87], a[4:7], v[168:171]
    v_cvt_pk_bf16_f32 v203, v206, v207
    v_mfma_f32_16x16x32_bf16 v[168:171], a[88:91], a[8:11], v[168:171]
    v_mfma_f32_16x16x32_bf16 v[168:171], a[92:95], a[12:15], v[168:171]
    v_exp_f32 v192, v192
    v_mfma_f32_16x16x32_bf16 v[172:175], a[96:99], a[0:3], v[208:211]
    v_mfma_f32_16x16x32_bf16 v[172:175], a[100:103], a[4:7], v[172:175]
    v_exp_f32 v193, v193
    v_mfma_f32_16x16x32_bf16 v[172:175], a[104:107], a[8:11], v[172:175]
    v_cvt_pk_bf16_f32 v192, v192, v193
    s_add_u32 m0, s30, 106496
    v_mfma_f32_16x16x32_bf16 v[172:175], a[108:111], a[12:15], v[172:175]
    v_exp_f32 v194, v194
    v_mfma_f32_16x16x32_bf16 v[176:179], a[80:83], a[16:19], v[212:215]
    buffer_load_dwordx4 v242, s[16:19], s32 offen nt lds
    v_mfma_f32_16x16x32_bf16 v[176:179], a[84:87], a[20:23], v[176:179]
    v_exp_f32 v195, v195
    v_mfma_f32_16x16x32_bf16 v[176:179], a[88:91], a[24:27], v[176:179]
    buffer_load_dwordx4 v243, s[16:19], s32 offen offset:1024 nt lds
    v_cvt_pk_bf16_f32 v193, v194, v195
    v_mfma_f32_16x16x32_bf16 v[176:179], a[92:95], a[28:31], v[176:179]
    v_exp_f32 v196, v196
    v_mfma_f32_16x16x32_bf16 v[180:183], a[96:99], a[16:19], v[212:215]
    s_add_u32 s32, s32, 16384
    v_mfma_f32_16x16x32_bf16 v[180:183], a[100:103], a[20:23], v[180:183]
    v_exp_f32 v197, v197
    v_mfma_f32_16x16x32_bf16 v[180:183], a[104:107], a[24:27], v[180:183]
    v_cvt_pk_bf16_f32 v194, v196, v197
    v_mfma_f32_16x16x32_bf16 v[180:183], a[108:111], a[28:31], v[180:183]
    v_exp_f32 v198, v198
    v_mfma_f32_16x16x32_bf16 v[136:139], a[112:115], v[200:203], v[136:139]
    v_mfma_f32_16x16x32_bf16 v[140:143], a[116:119], v[200:203], v[140:143]
    v_exp_f32 v199, v199
    v_mfma_f32_16x16x32_bf16 v[144:147], a[120:123], v[200:203], v[144:147]
    v_cvt_pk_bf16_f32 v195, v198, v199
    v_mfma_f32_16x16x32_bf16 v[148:151], a[124:127], v[200:203], v[148:151]
    v_mfma_f32_16x16x32_bf16 v[152:155], a[128:131], v[200:203], v[152:155]
    v_exp_f32 v168, v168
    v_mfma_f32_16x16x32_bf16 v[156:159], a[132:135], v[200:203], v[156:159]
    s_cmp_lt_u32 s49, 90112
    s_cbranch_scc1 L_pf0_2_0
L_pf0_2_0r:
    v_mfma_f32_16x16x32_bf16 v[160:163], a[136:139], v[200:203], v[160:163]
    v_exp_f32 v169, v169
    v_mfma_f32_16x16x32_bf16 v[164:167], a[140:143], v[200:203], v[164:167]
    v_cvt_pk_bf16_f32 v168, v168, v169
    v_mfma_f32_16x16x32_bf16 a[164:167], a[144:147], v[200:203], a[164:167]
    v_exp_f32 v170, v170
    v_mfma_f32_16x16x32_bf16 v[72:75], a[112:115], v[184:187], v[72:75]
    v_mfma_f32_16x16x32_bf16 v[104:107], a[112:115], v[192:195], v[104:107]
    v_exp_f32 v171, v171
    v_mfma_f32_16x16x32_bf16 v[76:79], a[116:119], v[184:187], v[76:79]
    ds_read_b64_tr_b16 a[112:113], v232 offset:8192
    v_cvt_pk_bf16_f32 v169, v170, v171
    v_mfma_f32_16x16x32_bf16 v[108:111], a[116:119], v[192:195], v[108:111]
    v_exp_f32 v172, v172
    v_mfma_f32_16x16x32_bf16 v[80:83], a[120:123], v[184:187], v[80:83]
    ds_read_b64_tr_b16 a[114:115], v232 offset:12288
    v_mfma_f32_16x16x32_bf16 v[112:115], a[120:123], v[192:195], v[112:115]
    v_exp_f32 v173, v173
    v_mfma_f32_16x16x32_bf16 v[84:87], a[124:127], v[184:187], v[84:87]
    ds_read_b64_tr_b16 a[116:117], v233 offset:8192
    v_cvt_pk_bf16_f32 v170, v172, v173
    v_mfma_f32_16x16x32_bf16 v[116:119], a[124:127], v[192:195], v[116:119]
    v_exp_f32 v174, v174
    v_mfma_f32_16x16x32_bf16 v[88:91], a[128:131], v[184:187], v[88:91]
    ds_read_b64_tr_b16 a[118:119], v233 offset:12288
    ds_read_b64_tr_b16 a[120:121], v234 offset:8192
    v_mfma_f32_16x16x32_bf16 v[120:123], a[128:131], v[192:195], v[120:123]
    v_exp_f32 v175, v175
    v_mfma_f32_16x16x32_bf16 v[92:95], a[132:135], v[184:187], v[92:95]
    ds_read_b64_tr_b16 a[122:123], v234 offset:12288
    v_cvt_pk_bf16_f32 v171, v174, v175
    v_mfma_f32_16x16x32_bf16 v[124:127], a[132:135], v[192:195], v[124:127]
    ds_read_b64_tr_b16 a[124:125], v235 offset:8192
    ds_read_b64_tr_b16 a[126:127], v235 offset:12288
    v_mfma_f32_16x16x32_bf16 v[96:99], a[136:139], v[184:187], v[96:99]
    v_exp_f32 v176, v176
    v_mfma_f32_16x16x32_bf16 v[128:131], a[136:139], v[192:195], v[128:131]
    ds_read_b64_tr_b16 a[128:129], v236 offset:8192
    ds_read_b64_tr_b16 a[130:131], v236 offset:12288
    v_mfma_f32_16x16x32_bf16 v[100:103], a[140:143], v[184:187], v[100:103]
    v_exp_f32 v177, v177
    v_mfma_f32_16x16x32_bf16 v[132:135], a[140:143], v[192:195], v[132:135]
    ds_read_b64_tr_b16 a[132:133], v237 offset:8192
    v_cvt_pk_bf16_f32 v176, v176, v177
    v_mfma_f32_16x16x32_bf16 a[156:159], a[144:147], v[184:187], a[156:159]
    v_exp_f32 v178, v178
    v_mfma_f32_16x16x32_bf16 a[160:163], a[144:147], v[192:195], a[160:163]
    ds_read_b64_tr_b16 a[134:135], v237 offset:12288
    ds_read_b64_tr_b16 a[136:137], v238 offset:8192
    v_mfma_f32_16x16x32_bf16 v[184:187], a[80:83], a[32:35], v[216:219]
    v_exp_f32 v179, v179
    v_mfma_f32_16x16x32_bf16 v[184:187], a[84:87], a[36:39], v[184:187]
    v_cvt_pk_bf16_f32 v177, v178, v179
    s_add_u32 m0, s30, 49152
    v_mfma_f32_16x16x32_bf16 v[184:187], a[88:91], a[40:43], v[184:187]
    v_exp_f32 v180, v180
    v_mfma_f32_16x16x32_bf16 v[184:187], a[92:95], a[44:47], v[184:187]
    buffer_load_dwordx4 v240, s[12:15], s31 offen nt lds
    ds_read_b64_tr_b16 a[138:139], v238 offset:12288
    v_mfma_f32_16x16x32_bf16 v[188:191], a[96:99], a[32:35], v[216:219]
    v_exp_f32 v181, v181
    v_mfma_f32_16x16x32_bf16 v[188:191], a[100:103], a[36:39], v[188:191]
    buffer_load_dwordx4 v241, s[12:15], s31 offen offset:1024 nt lds
    v_cvt_pk_bf16_f32 v178, v180, v181
    v_mfma_f32_16x16x32_bf16 v[188:191], a[104:107], a[40:43], v[188:191]
    v_exp_f32 v182, v182
    v_mfma_f32_16x16x32_bf16 v[188:191], a[108:111], a[44:47], v[188:191]
    ds_read_b64_tr_b16 a[140:141], v239 offset:8192
    ds_read_b64_tr_b16 a[142:143], v239 offset:12288
    v_mfma_f32_16x16x32_bf16 v[192:195], a[80:83], a[48:51], v[220:223]
    v_exp_f32 v183, v183
    v_mfma_f32_16x16x32_bf16 v[192:195], a[84:87], a[52:55], v[192:195]
    v_cvt_pk_bf16_f32 v179, v182, v183
    v_mfma_f32_16x16x32_bf16 v[192:195], a[88:91], a[56:59], v[192:195]
    ds_read_b128 a[80:83], v228 offset:16384
    v_mfma_f32_16x16x32_bf16 v[192:195], a[92:95], a[60:63], v[192:195]
    v_exp_f32 v184, v184
    v_mfma_f32_16x16x32_bf16 v[196:199], a[96:99], a[48:51], v[220:223]
    ds_read_b128 a[84:87], v229 offset:16384
    v_mfma_f32_16x16x32_bf16 v[196:199], a[100:103], a[52:55], v[196:199]
    v_exp_f32 v185, v185
    v_mfma_f32_16x16x32_bf16 v[196:199], a[104:107], a[56:59], v[196:199]
    v_cvt_pk_bf16_f32 v184, v184, v185
    v_mfma_f32_16x16x32_bf16 v[196:199], a[108:111], a[60:63], v[196:199]
    ds_read_b128 a[88:91], v230 offset:16384
    s_waitcnt lgkmcnt(3)
    v_mfma_f32_16x16x32_bf16 v[8:11], a[112:115], v[168:171], v[8:11]
    v_exp_f32 v186, v186
    v_mfma_f32_16x16x32_bf16 v[12:15], a[116:119], v[168:171], v[12:15]
    ds_read_b128 a[92:95], v231 offset:16384
    v_mfma_f32_16x16x32_bf16 v[16:19], a[120:123], v[168:171], v[16:19]
    v_exp_f32 v187, v187
    v_mfma_f32_16x16x32_bf16 v[20:23], a[124:127], v[168:171], v[20:23]
    ds_read_b128 a[96:99], v228 offset:20480
    v_cvt_pk_bf16_f32 v185, v186, v187
    v_mfma_f32_16x16x32_bf16 v[24:27], a[128:131], v[168:171], v[24:27]
    v_exp_f32 v188, v188
    v_mfma_f32_16x16x32_bf16 v[28:31], a[132:135], v[168:171], v[28:31]
    ds_read_b128 a[100:103], v229 offset:20480
    v_mfma_f32_16x16x32_bf16 v[32:35], a[136:139], v[168:171], v[32:35]
    v_exp_f32 v189, v189
    v_mfma_f32_16x16x32_bf16 v[36:39], a[140:143], v[168:171], v[36:39]
    ds_read_b128 a[104:107], v230 offset:20480
    v_cvt_pk_bf16_f32 v186, v188, v189
    v_mfma_f32_16x16x32_bf16 a[148:151], a[144:147], v[168:171], a[148:151]
    v_exp_f32 v190, v190
    v_mfma_f32_16x16x32_bf16 v[40:43], a[112:115], v[176:179], v[40:43]
    ds_read_b128 a[108:111], v231 offset:20480
    v_mfma_f32_16x16x32_bf16 v[44:47], a[116:119], v[176:179], v[44:47]
    v_exp_f32 v191, v191
    v_mfma_f32_16x16x32_bf16 v[48:51], a[120:123], v[176:179], v[48:51]
    v_cvt_pk_bf16_f32 v187, v190, v191
    v_mfma_f32_16x16x32_bf16 v[52:55], a[124:127], v[176:179], v[52:55]
    v_exp_f32 v192, v192
    v_mfma_f32_16x16x32_bf16 v[56:59], a[128:131], v[176:179], v[56:59]
    v_mfma_f32_16x16x32_bf16 v[60:63], a[132:135], v[176:179], v[60:63]
    v_exp_f32 v193, v193
    v_mfma_f32_16x16x32_bf16 v[64:67], a[136:139], v[176:179], v[64:67]
    v_cvt_pk_bf16_f32 v192, v192, v193
    v_mfma_f32_16x16x32_bf16 v[68:71], a[140:143], v[176:179], v[68:71]
    v_exp_f32 v194, v194
    v_mfma_f32_16x16x32_bf16 a[152:155], a[144:147], v[176:179], a[152:155]
    s_waitcnt lgkmcnt(0)
    v_mfma_f32_16x16x32_bf16 v[168:171], a[80:83], a[0:3], v[208:211]
    s_waitcnt vmcnt(8)
    s_barrier
L_in0_1:
    v_mfma_f32_16x16x32_bf16 v[168:171], a[84:87], a[4:7], v[168:171]
    v_exp_f32 v195, v195
    v_mfma_f32_16x16x32_bf16 v[168:171], a[88:91], a[8:11], v[168:171]
    v_cvt_pk_bf16_f32 v193, v194, v195
    s_add_u32 m0, s30, 114688
    v_mfma_f32_16x16x32_bf16 v[168:171], a[92:95], a[12:15], v[168:171]
    v_exp_f32 v196, v196
    v_mfma_f32_16x16x32_bf16 v[172:175], a[96:99], a[0:3], v[208:211]
    buffer_load_dwordx4 v242, s[16:19], s31 offen nt lds
    v_mfma_f32_16x16x32_bf16 v[172:175], a[100:103], a[4:7], v[172:175]
    v_exp_f32 v197, v197
    v_mfma_f32_16x16x32_bf16 v[172:175], a[104:107], a[8:11], v[172:175]
    buffer_load_dwordx4 v243, s[16:19], s31 offen offset:1024 nt lds
    v_cvt_pk_bf16_f32 v194, v196, v197
    v_mfma_f32_16x16x32_bf16 v[172:175], a[108:111], a[12:15], v[172:175]
    v_exp_f32 v198, v198
    v_mfma_f32_16x16x32_bf16 v[176:179], a[80:83], a[16:19], v[212:215]
    s_add_u32 s31, s31, 16384
    v_mfma_f32_16x16x32_bf16 v[176:179], a[84:87], a[20:23], v[176:179]
    v_exp_f32 v199, v199
    v_mfma_f32_16x16x32_bf16 v[176:179], a[88:91], a[24:27], v[176:179]
    v_cvt_pk_bf16_f32 v195, v198, v199
    v_mfma_f32_16x16x32_bf16 v[176:179], a[92:95], a[28:31], v[176:179]
    v_exp_f32 v168, v168
    v_mfma_f32_16x16x32_bf16 v[180:183], a[96:99], a[16:19], v[212:215]
    s_cmp_lt_u32 s49, 90112
    s_cbranch_scc1 L_pf0_0_1
L_pf0_0_1r:
    v_mfma_f32_16x16x32_bf16 v[180:183], a[100:103], a[20:23], v[180:183]
    v_exp_f32 v169, v169
    v_mfma_f32_16x16x32_bf16 v[180:183], a[104:107], a[24:27], v[180:183]
    v_cvt_pk_bf16_f32 v168, v168, v169
    v_mfma_f32_16x16x32_bf16 v[180:183], a[108:111], a[28:31], v[180:183]
    v_exp_f32 v170, v170
    v_mfma_f32_16x16x32_bf16 v[72:75], a[112:115], v[184:187], v[72:75]
    v_mfma_f32_16x16x32_bf16 v[104:107], a[112:115], v[192:195], v[104:107]
    v_exp_f32 v171, v171
    v_mfma_f32_16x16x32_bf16 v[76:79], a[116:119], v[184:187], v[76:79]
    ds_read_b64_tr_b16 a[112:113], v232 offset:16384
    v_cvt_pk_bf16_f32 v169, v170, v171
    v_mfma_f32_16x16x32_bf16 v[108:111], a[116:119], v[192:195], v[108:111]
    v_exp_f32 v172, v172
    v_mfma_f32_16x16x32_bf16 v[80:83], a[120:123], v[184:187], v[80:83]
    ds_read_b64_tr_b16 a[114:115], v232 offset:20480
    v_mfma_f32_16x16x32_bf16 v[112:115], a[120:123], v[192:195], v[112:115]
    v_exp_f32 v173, v173
    v_mfma_f32_16x16x32_bf16 v[84:87], a[124:127], v[184:187], v[84:87]
    ds_read_b64_tr_b16 a[116:117], v233 offset:16384
    v_cvt_pk_bf16_f32 v170, v172, v173
    v_mfma_f32_16x16x32_bf16 v[116:119], a[124:127], v[192:195], v[116:119]
    v_exp_f32 v174, v174
    v_mfma_f32_16x16x32_bf16 v[88:91], a[128:131], v[184:187], v[88:91]
    ds_read_b64_tr_b16 a[118:119], v233 offset:20480
    v_mfma_f32_16x16x32_bf16 v[120:123], a[128:131], v[192:195], v[120:123]
    v_exp_f32 v175, v175
    v_mfma_f32_16x16x32_bf16 v[92:95], a[132:135], v[184:187], v[92:95]
    v_cvt_pk_bf16_f32 v171, v174, v175
    v_mfma_f32_16x16x32_bf16 v[124:127], a[132:135], v[192:195], v[124:127]
    ds_read_b64_tr_b16 a[120:121], v234 offset:16384
    v_mfma_f32_16x16x32_bf16 v[96:99], a[136:139], v[184:187], v[96:99]
    v_exp_f32 v176, v176
    v_mfma_f32_16x16x32_bf16 v[128:131], a[136:139], v[192:195], v[128:131]
    ds_read_b64_tr_b16 a[122:123], v234 offset:20480
    v_mfma_f32_16x16x32_bf16 v[100:103], a[140:143], v[184:187], v[100:103]
    v_exp_f32 v177, v177
    v_mfma_f32_16x16x32_bf16 v[132:135], a[140:143], v[192:195], v[132:135]
    ds_read_b64_tr_b16 a[124:125], v235 offset:16384
    v_cvt_pk_bf16_f32 v176, v176, v177
    v_mfma_f32_16x16x32_bf16 a[156:159], a[144:147], v[184:187], a[156:159]
    v_exp_f32 v178, v178
    v_mfma_f32_16x16x32_bf16 a[160:163], a[144:147], v[192:195], a[160:163]
    ds_read_b64_tr_b16 a[126:127], v235 offset:20480
    v_mfma_f32_16x16x32_bf16 v[200:203], a[80:83], a[64:67], v[224:227]
    v_exp_f32 v179, v179
    v_mfma_f32_16x16x32_bf16 v[200:203], a[84:87], a[68:71], v[200:203]
    ds_read_b64_tr_b16 a[128:129], v236 offset:16384
    v_cvt_pk_bf16_f32 v177, v178, v179
    v_mfma_f32_16x16x32_bf16 v[200:203], a[88:91], a[72:75], v[200:203]
    v_exp_f32 v180, v180
    v_mfma_f32_16x16x32_bf16 v[200:203], a[92:95], a[76:79], v[200:203]
    ds_read_b64_tr_b16 a[130:131], v236 offset:20480
    v_mfma_f32_16x16x32_bf16 v[204:207], a[96:99], a[64:67], v[224:227]
    v_exp_f32 v181, v181
    v_mfma_f32_16x16x32_bf16 v[204:207], a[100:103], a[68:71], v[204:207]
    ds_read_b64_tr_b16 a[132:133], v237 offset:16384
    v_cvt_pk_bf16_f32 v178, v180, v181
    v_mfma_f32_16x16x32_bf16 v[204:207], a[104:107], a[72:75], v[204:207]
    v_exp_f32 v182, v182
    v_mfma_f32_16x16x32_bf16 v[204:207], a[108:111], a[76:79], v[204:207]
    ds_read_b64_tr_b16 a[134:135], v237 offset:20480
    v_mfma_f32_16x16x32_bf16 v[184:187], a[80:83], a[32:35], v[216:219]
    v_exp_f32 v183, v183
    v_mfma_f32_16x16x32_bf16 v[184:187], a[84:87], a[36:39], v[184:187]
    v_cvt_pk_bf16_f32 v179, v182, v183
    s_add_u32 m0, s30, 57344
    v_mfma_f32_16x16x32_bf16 v[184:187], a[88:91], a[40:43], v[184:187]
    buffer_load_dwordx4 v240, s[12:15], s32 offen nt lds
    ds_read_b64_tr_b16 a[136:137], v238 offset:16384
    v_mfma_f32_16x16x32_bf16 v[184:187], a[92:95], a[44:47], v[184:187]
    v_exp_f32 v200, v200
    v_mfma_f32_16x16x32_bf16 v[188:191], a[96:99], a[32:35], v[216:219]
    buffer_load_dwordx4 v241, s[12:15], s32 offen offset:1024 nt lds
    ds_read_b64_tr_b16 a[138:139], v238 offset:20480
    v_mfma_f32_16x16x32_bf16 v[188:191], a[100:103], a[36:39], v[188:191]
    v_exp_f32 v201, v201
    v_mfma_f32_16x16x32_bf16 v[188:191], a[104:107], a[40:43], v[188:191]
    ds_read_b64_tr_b16 a[140:141], v239 offset:16384
    v_cvt_pk_bf16_f32 v200, v200, v201
    v_mfma_f32_16x16x32_bf16 v[188:191], a[108:111], a[44:47], v[188:191]
    v_exp_f32 v202, v202
    v_mfma_f32_16x16x32_bf16 v[192:195], a[80:83], a[48:51], v[220:223]
    ds_read_b64_tr_b16 a[142:143], v239 offset:20480
    v_mfma_f32_16x16x32_bf16 v[192:195], a[84:87], a[52:55], v[192:195]
    v_exp_f32 v203, v203
    v_mfma_f32_16x16x32_bf16 v[192:195], a[88:91], a[56:59], v[192:195]
    ds_read_b128 a[80:83], v228 offset:24576
    v_cvt_pk_bf16_f32 v201, v202, v203
    v_mfma_f32_16x16x32_bf16 v[192:195], a[92:95], a[60:63], v[192:195]
    v_exp_f32 v184, v184
    v_mfma_f32_16x16x32_bf16 v[196:199], a[96:99], a[48:51], v[220:223]
    ds_read_b128 a[84:87], v229 offset:24576
    v_mfma_f32_16x16x32_bf16 v[196:199], a[100:103], a[52:55], v[196:199]
    v_exp_f32 v185, v185
    v_mfma_f32_16x16x32_bf16 v[196:199], a[104:107], a[56:59], v[196:199]
    v_cvt_pk_bf16_f32 v184, v184, v185
    v_mfma_f32_16x16x32_bf16 v[196:199], a[108:111], a[60:63], v[196:199]
    ds_read_b128 a[88:91], v230 offset:24576
    s_waitcnt lgkmcnt(3)
    v_mfma_f32_16x16x32_bf16 v[8:11], a[112:115], v[168:171], v[8:11]
    v_exp_f32 v186, v186
    v_mfma_f32_16x16x32_bf16 v[12:15], a[116:119], v[168:171], v[12:15]
    ds_read_b128 a[92:95], v231 offset:24576
    v_mfma_f32_16x16x32_bf16 v[16:19], a[120:123], v[168:171], v[16:19]
    v_exp_f32 v187, v187
    v_mfma_f32_16x16x32_bf16 v[20:23], a[124:127], v[168:171], v[20:23]
    ds_read_b128 a[96:99], v228 offset:28672
    v_cvt_pk_bf16_f32 v185, v186, v187
    v_mfma_f32_16x16x32_bf16 v[24:27], a[128:131], v[168:171], v[24:27]
    v_exp_f32 v188, v188
    v_mfma_f32_16x16x32_bf16 v[28:31], a[132:135], v[168:171], v[28:31]
    ds_read_b128 a[100:103], v229 offset:28672
    v_mfma_f32_16x16x32_bf16 v[32:35], a[136:139], v[168:171], v[32:35]
    v_exp_f32 v189, v189
    v_mfma_f32_16x16x32_bf16 v[36:39], a[140:143], v[168:171], v[36:39]
    ds_read_b128 a[104:107], v230 offset:28672
    v_cvt_pk_bf16_f32 v186, v188, v189
    v_mfma_f32_16x16x32_bf16 a[148:151], a[144:147], v[168:171], a[148:151]
    v_exp_f32 v190, v190
    v_mfma_f32_16x16x32_bf16 v[40:43], a[112:115], v[176:179], v[40:43]
    ds_read_b128 a[108:111], v231 offset:28672
    v_mfma_f32_16x16x32_bf16 v[44:47], a[116:119], v[176:179], v[44:47]
    v_exp_f32 v191, v191
    v_mfma_f32_16x16x32_bf16 v[48:51], a[120:123], v[176:179], v[48:51]
    v_cvt_pk_bf16_f32 v187, v190, v191
    v_mfma_f32_16x16x32_bf16 v[52:55], a[124:127], v[176:179], v[52:55]
    v_exp_f32 v204, v204
    v_mfma_f32_16x16x32_bf16 v[56:59], a[128:131], v[176:179], v[56:59]
    s_cmp_lt_u32 s49, 90112
    s_cbranch_scc1 L_pf0_1_1
L_pf0_1_1r:
    v_mfma_f32_16x16x32_bf16 v[60:63], a[132:135], v[176:179], v[60:63]
    v_exp_f32 v205, v205
    v_mfma_f32_16x16x32_bf16 v[64:67], a[136:139], v[176:179], v[64:67]
    v_cvt_pk_bf16_f32 v202, v204, v205
    v_mfma_f32_16x16x32_bf16 v[68:71], a[140:143], v[176:179], v[68:71]
    v_exp_f32 v206, v206
    v_mfma_f32_16x16x32_bf16 a[152:155], a[144:147], v[176:179], a[152:155]
    s_waitcnt lgkmcnt(0)
    v_mfma_f32_16x16x32_bf16 v[168:171], a[80:83], a[0:3], v[208:211]
    v_exp_f32 v207, v207
    v_mfma_f32_16x16x32_bf16 v[168:171], a[84:87], a[4:7], v[168:171]
    v_cvt_pk_bf16_f32 v203, v206, v207
    v_mfma_f32_16x16x32_bf16 v[168:171], a[88:91], a[8:11], v[168:171]
    v_mfma_f32_16x16x32_bf16 v[168:171], a[92:95], a[12:15], v[168:171]
    v_exp_f32 v192, v192
    v_mfma_f32_16x16x32_bf16 v[172:175], a[96:99], a[0:3], v[208:211]
    v_mfma_f32_16x16x32_bf16 v[172:175], a[100:103], a[4:7], v[172:175]
    v_exp_f32 v193, v193
    v_mfma_f32_16x16x32_bf16 v[172:175], a[104:107], a[8:11], v[172:175]
    v_cvt_pk_bf16_f32 v192, v192, v193
    s_add_u32 m0, s30, 122880
    v_mfma_f32_16x16x32_bf16 v[172:175], a[108:111], a[12:15], v[172:175]
    v_exp_f32 v194, v194
    v_mfma_f32_16x16x32_bf16 v[176:179], a[80:83], a[16:19], v[212:215]
    buffer_load_dwordx4 v242, s[16:19], s32 offen nt lds
    v_mfma_f32_16x16x32_bf16 v[176:179], a[84:87], a[20:23], v[176:179]
    v_exp_f32 v195, v195
    v_mfma_f32_16x16x32_bf16 v[176:179], a[88:91], a[24:27], v[176:179]
    buffer_load_dwordx4 v243, s[16:19], s32 offen offset:1024 nt lds
    v_cvt_pk_bf16_f32 v193, v194, v195
    v_mfma_f32_16x16x32_bf16 v[176:179], a[92:95], a[28:31], v[176:179]
    v_exp_f32 v196, v196
    v_mfma_f32_16x16x32_bf16 v[180:183], a[96:99], a[16:19], v[212:215]
    s_add_u32 s32, s32, 16384
    v_mfma_f32_16x16x32_bf16 v[180:183], a[100:103], a[20:23], v[180:183]
    v_exp_f32 v197, v197
    v_mfma_f32_16x16x32_bf16 v[180:183], a[104:107], a[24:27], v[180:183]
    v_cvt_pk_bf16_f32 v194, v196, v197
    v_mfma_f32_16x16x32_bf16 v[180:183], a[108:111], a[28:31], v[180:183]
    v_exp_f32 v198, v198
    v_mfma_f32_16x16x32_bf16 v[136:139], a[112:115], v[200:203], v[136:139]
    v_mfma_f32_16x16x32_bf16 v[140:143], a[116:119], v[200:203], v[140:143]
    v_exp_f32 v199, v199
    v_mfma_f32_16x16x32_bf16 v[144:147], a[120:123], v[200:203], v[144:147]
    v_cvt_pk_bf16_f32 v195, v198, v199
    v_mfma_f32_16x16x32_bf16 v[148:151], a[124:127], v[200:203], v[148:151]
    v_mfma_f32_16x16x32_bf16 v[152:155], a[128:131], v[200:203], v[152:155]
    v_exp_f32 v168, v168
    v_mfma_f32_16x16x32_bf16 v[156:159], a[132:135], v[200:203], v[156:159]
    s_cmp_lt_u32 s49, 90112
    s_cbranch_scc1 L_pf0_2_1
L_pf0_2_1r:
    v_mfma_f32_16x16x32_bf16 v[160:163], a[136:139], v[200:203], v[160:163]
    v_exp_f32 v169, v169
    v_mfma_f32_16x16x32_bf16 v[164:167], a[140:143], v[200:203], v[164:167]
    v_cvt_pk_bf16_f32 v168, v168, v169
    v_mfma_f32_16x16x32_bf16 a[164:167], a[144:147], v[200:203], a[164:167]
    v_exp_f32 v170, v170
    v_mfma_f32_16x16x32_bf16 v[72:75], a[112:115], v[184:187], v[72:75]
    v_mfma_f32_16x16x32_bf16 v[104:107], a[112:115], v[192:195], v[104:107]
    v_exp_f32 v171, v171
    v_mfma_f32_16x16x32_bf16 v[76:79], a[116:119], v[184:187], v[76:79]
    ds_read_b64_tr_b16 a[112:113], v232 offset:24576
    v_cvt_pk_bf16_f32 v169, v170, v171
    v_mfma_f32_16x16x32_bf16 v[108:111], a[116:119], v[192:195], v[108:111]
    v_exp_f32 v172, v172
    v_mfma_f32_16x16x32_bf16 v[80:83], a[120:123], v[184:187], v[80:83]
    ds_read_b64_tr_b16 a[114:115], v232 offset:28672
    v_mfma_f32_16x16x32_bf16 v[112:115], a[120:123], v[192:195], v[112:115]
    v_exp_f32 v173, v173
    v_mfma_f32_16x16x32_bf16 v[84:87], a[124:127], v[184:187], v[84:87]
    ds_read_b64_tr_b16 a[116:117], v233 offset:24576
    v_cvt_pk_bf16_f32 v170, v172, v173
    v_mfma_f32_16x16x32_bf16 v[116:119], a[124:127], v[192:195], v[116:119]
    v_exp_f32 v174, v174
    v_mfma_f32_16x16x32_bf16 v[88:91], a[128:131], v[184:187], v[88:91]
    ds_read_b64_tr_b16 a[118:119], v233 offset:28672
    ds_read_b64_tr_b16 a[120:121], v234 offset:24576
    v_mfma_f32_16x16x32_bf16 v[120:123], a[128:131], v[192:195], v[120:123]
    v_exp_f32 v175, v175
    v_mfma_f32_16x16x32_bf16 v[92:95], a[132:135], v[184:187], v[92:95]
    ds_read_b64_tr_b16 a[122:123], v234 offset:28672
    v_cvt_pk_bf16_f32 v171, v174, v175
    v_mfma_f32_16x16x32_bf16 v[124:127], a[132:135], v[192:195], v[124:127]
    ds_read_b64_tr_b16 a[124:125], v235 offset:24576
    ds_read_b64_tr_b16 a[126:127], v235 offset:28672
    v_mfma_f32_16x16x32_bf16 v[96:99], a[136:139], v[184:187], v[96:99]
    v_exp_f32 v176, v176
    v_mfma_f32_16x16x32_bf16 v[128:131], a[136:139], v[192:195], v[128:131]
    ds_read_b64_tr_b16 a[128:129], v236 offset:24576
    ds_read_b64_tr_b16 a[130:131], v236 offset:28672
    v_mfma_f32_16x16x32_bf16 v[100:103], a[140:143], v[184:187], v[100:103]
    v_exp_f32 v177, v177
    v_mfma_f32_16x16x32_bf16 v[132:135], a[140:143], v[192:195], v[132:135]
    ds_read_b64_tr_b16 a[132:133], v237 offset:24576
    v_cvt_pk_bf16_f32 v176, v176, v177
    v_mfma_f32_16x16x32_bf16 a[156:159], a[144:147], v[184:187], a[156:159]
    v_exp_f32 v178, v178
    v_mfma_f32_16x16x32_bf16 a[160:163], a[144:147], v[192:195], a[160:163]
    ds_read_b64_tr_b16 a[134:135], v237 offset:28672
    ds_read_b64_tr_b16 a[136:137], v238 offset:24576
    v_mfma_f32_16x16x32_bf16 v[184:187], a[80:83], a[32:35], v[216:219]
    v_exp_f32 v179, v179
    v_mfma_f32_16x16x32_bf16 v[184:187], a[84:87], a[36:39], v[184:187]
    v_cvt_pk_bf16_f32 v177, v178, v179
    s_add_u32 m0, s30, 0
    v_mfma_f32_16x16x32_bf16 v[184:187], a[88:91], a[40:43], v[184:187]
    v_exp_f32 v180, v180
    v_mfma_f32_16x16x32_bf16 v[184:187], a[92:95], a[44:47], v[184:187]
    buffer_load_dwordx4 v240, s[12:15], s31 offen nt lds
    ds_read_b64_tr_b16 a[138:139], v238 offset:28672
    v_mfma_f32_16x16x32_bf16 v[188:191], a[96:99], a[32:35], v[216:219]
    v_exp_f32 v181, v181
    v_mfma_f32_16x16x32_bf16 v[188:191], a[100:103], a[36:39], v[188:191]
    buffer_load_dwordx4 v241, s[12:15], s31 offen offset:1024 nt lds
    v_cvt_pk_bf16_f32 v178, v180, v181
    v_mfma_f32_16x16x32_bf16 v[188:191], a[104:107], a[40:43], v[188:191]
    v_exp_f32 v182, v182
    v_mfma_f32_16x16x32_bf16 v[188:191], a[108:111], a[44:47], v[188:191]
    ds_read_b64_tr_b16 a[140:141], v239 offset:24576
    ds_read_b64_tr_b16 a[142:143], v239 offset:28672
    v_mfma_f32_16x16x32_bf16 v[192:195], a[80:83], a[48:51], v[220:223]
    v_exp_f32 v183, v183
    v_mfma_f32_16x16x32_bf16 v[192:195], a[84:87], a[52:55], v[192:195]
    v_cvt_pk_bf16_f32 v179, v182, v183
    v_mfma_f32_16x16x32_bf16 v[192:195], a[88:91], a[56:59], v[192:195]
    ds_read_b128 a[80:83], v228 offset:32768
    v_mfma_f32_16x16x32_bf16 v[192:195], a[92:95], a[60:63], v[192:195]
    v_exp_f32 v184, v184
    v_mfma_f32_16x16x32_bf16 v[196:199], a[96:99], a[48:51], v[220:223]
    ds_read_b128 a[84:87], v229 offset:32768
    v_mfma_f32_16x16x32_bf16 v[196:199], a[100:103], a[52:55], v[196:199]
    v_exp_f32 v185, v185
    v_mfma_f32_16x16x32_bf16 v[196:199], a[104:107], a[56:59], v[196:199]
    v_cvt_pk_bf16_f32 v184, v184, v185
    v_mfma_f32_16x16x32_bf16 v[196:199], a[108:111], a[60:63], v[196:199]
    ds_read_b128 a[88:91], v230 offset:32768
    s_waitcnt lgkmcnt(3)
    v_mfma_f32_16x16x32_bf16 v[8:11], a[112:115], v[168:171], v[8:11]
    v_exp_f32 v186, v186
    v_mfma_f32_16x16x32_bf16 v[12:15], a[116:119], v[168:171], v[12:15]
    ds_read_b128 a[92:95], v231 offset:32768
    v_mfma_f32_16x16x32_bf16 v[16:19], a[120:123], v[168:171], v[16:19]
    v_exp_f32 v187, v187
    v_mfma_f32_16x16x32_bf16 v[20:23], a[124:127], v[168:171], v[20:23]
    ds_read_b128 a[96:99], v228 offset:36864
    v_cvt_pk_bf16_f32 v185, v186, v187
    v_mfma_f32_16x16x32_bf16 v[24:27], a[128:131], v[168:171], v[24:27]
    v_exp_f32 v188, v188
    v_mfma_f32_16x16x32_bf16 v[28:31], a[132:135], v[168:171], v[28:31]
    ds_read_b128 a[100:103], v229 offset:36864
    v_mfma_f32_16x16x32_bf16 v[32:35], a[136:139], v[168:171], v[32:35]
    v_exp_f32 v189, v189
    v_mfma_f32_16x16x32_bf16 v[36:39], a[140:143], v[168:171], v[36:39]
    ds_read_b128 a[104:107], v230 offset:36864
    v_cvt_pk_bf16_f32 v186, v188, v189
    v_mfma_f32_16x16x32_bf16 a[148:151], a[144:147], v[168:171], a[148:151]
    v_exp_f32 v190, v190
    v_mfma_f32_16x16x32_bf16 v[40:43], a[112:115], v[176:179], v[40:43]
    ds_read_b128 a[108:111], v231 offset:36864
    v_mfma_f32_16x16x32_bf16 v[44:47], a[116:119], v[176:179], v[44:47]
    v_exp_f32 v191, v191
    v_mfma_f32_16x16x32_bf16 v[48:51], a[120:123], v[176:179], v[48:51]
    v_cvt_pk_bf16_f32 v187, v190, v191
    v_mfma_f32_16x16x32_bf16 v[52:55], a[124:127], v[176:179], v[52:55]
    v_exp_f32 v192, v192
    v_mfma_f32_16x16x32_bf16 v[56:59], a[128:131], v[176:179], v[56:59]
    v_mfma_f32_16x16x32_bf16 v[60:63], a[132:135], v[176:179], v[60:63]
    v_exp_f32 v193, v193
    v_mfma_f32_16x16x32_bf16 v[64:67], a[136:139], v[176:179], v[64:67]
    v_cvt_pk_bf16_f32 v192, v192, v193
    v_mfma_f32_16x16x32_bf16 v[68:71], a[140:143], v[176:179], v[68:71]
    v_exp_f32 v194, v194
    v_mfma_f32_16x16x32_bf16 a[152:155], a[144:147], v[176:179], a[152:155]
    s_waitcnt lgkmcnt(0)
    v_mfma_f32_16x16x32_bf16 v[168:171], a[80:83], a[0:3], v[208:211]
    s_waitcnt vmcnt(8)
    s_barrier
L_in0_2:
    v_mfma_f32_16x16x32_bf16 v[168:171], a[84:87], a[4:7], v[168:171]
    v_exp_f32 v195, v195
    v_mfma_f32_16x16x32_bf16 v[168:171], a[88:91], a[8:11], v[168:171]
    v_cvt_pk_bf16_f32 v193, v194, v195
    s_add_u32 m0, s30, 65536
    v_mfma_f32_16x16x32_bf16 v[168:171], a[92:95], a[12:15], v[168:171]
    v_exp_f32 v196, v196
    v_mfma_f32_16x16x32_bf16 v[172:175], a[96:99], a[0:3], v[208:211]
    buffer_load_dwordx4 v242, s[16:19], s31 offen nt lds
    v_mfma_f32_16x16x32_bf16 v[172:175], a[100:103], a[4:7], v[172:175]
    v_exp_f32 v197, v197
    v_mfma_f32_16x16x32_bf16 v[172:175], a[104:107], a[8:11], v[172:175]
    buffer_load_dwordx4 v243, s[16:19], s31 offen offset:1024 nt lds
    v_cvt_pk_bf16_f32 v194, v196, v197
    v_mfma_f32_16x16x32_bf16 v[172:175], a[108:111], a[12:15], v[172:175]
    v_exp_f32 v198, v198
    v_mfma_f32_16x16x32_bf16 v[176:179], a[80:83], a[16:19], v[212:215]
    s_add_u32 s31, s31, 16384
    v_mfma_f32_16x16x32_bf16 v[176:179], a[84:87], a[20:23], v[176:179]
    v_exp_f32 v199, v199
    v_mfma_f32_16x16x32_bf16 v[176:179], a[88:91], a[24:27], v[176:179]
    v_cvt_pk_bf16_f32 v195, v198, v199
    v_mfma_f32_16x16x32_bf16 v[176:179], a[92:95], a[28:31], v[176:179]
    v_exp_f32 v168, v168
    v_mfma_f32_16x16x32_bf16 v[180:183], a[96:99], a[16:19], v[212:215]
    s_cmp_lt_u32 s49, 90112
    s_cbranch_scc1 L_pf0_0_2
L_pf0_0_2r:
    v_mfma_f32_16x16x32_bf16 v[180:183], a[100:103], a[20:23], v[180:183]
    v_exp_f32 v169, v169
    v_mfma_f32_16x16x32_bf16 v[180:183], a[104:107], a[24:27], v[180:183]
    v_cvt_pk_bf16_f32 v168, v168, v169
    v_mfma_f32_16x16x32_bf16 v[180:183], a[108:111], a[28:31], v[180:183]
    v_exp_f32 v170, v170
    v_mfma_f32_16x16x32_bf16 v[72:75], a[112:115], v[184:187], v[72:75]
    v_mfma_f32_16x16x32_bf16 v[104:107], a[112:115], v[192:195], v[104:107]
    v_exp_f32 v171, v171
    v_mfma_f32_16x16x32_bf16 v[76:79], a[116:119], v[184:187], v[76:79]
    ds_read_b64_tr_b16 a[112:113], v232 offset:32768
    v_cvt_pk_bf16_f32 v169, v170, v171
    v_mfma_f32_16x16x32_bf16 v[108:111], a[116:119], v[192:195], v[108:111]
    v_exp_f32 v172, v172
    v_mfma_f32_16x16x32_bf16 v[80:83], a[120:123], v[184:187], v[80:83]
    ds_read_b64_tr_b16 a[114:115], v232 offset:36864
    v_mfma_f32_16x16x32_bf16 v[112:115], a[120:123], v[192:195], v[112:115]
    v_exp_f32 v173, v173
    v_mfma_f32_16x16x32_bf16 v[84:87], a[124:127], v[184:187], v[84:87]
    ds_read_b64_tr_b16 a[116:117], v233 offset:32768
    v_cvt_pk_bf16_f32 v170, v172, v173
    v_mfma_f32_16x16x32_bf16 v[116:119], a[124:127], v[192:195], v[116:119]
    v_exp_f32 v174, v174
    v_mfma_f32_16x16x32_bf16 v[88:91], a[128:131], v[184:187], v[88:91]
    ds_read_b64_tr_b16 a[118:119], v233 offset:36864
    v_mfma_f32_16x16x32_bf16 v[120:123], a[128:131], v[192:195], v[120:123]
    v_exp_f32 v175, v175
    v_mfma_f32_16x16x32_bf16 v[92:95], a[132:135], v[184:187], v[92:95]
    v_cvt_pk_bf16_f32 v171, v174, v175
    v_mfma_f32_16x16x32_bf16 v[124:127], a[132:135], v[192:195], v[124:127]
    ds_read_b64_tr_b16 a[120:121], v234 offset:32768
    v_mfma_f32_16x16x32_bf16 v[96:99], a[136:139], v[184:187], v[96:99]
    v_exp_f32 v176, v176
    v_mfma_f32_16x16x32_bf16 v[128:131], a[136:139], v[192:195], v[128:131]
    ds_read_b64_tr_b16 a[122:123], v234 offset:36864
    v_mfma_f32_16x16x32_bf16 v[100:103], a[140:143], v[184:187], v[100:103]
    v_exp_f32 v177, v177
    v_mfma_f32_16x16x32_bf16 v[132:135], a[140:143], v[192:195], v[132:135]
    ds_read_b64_tr_b16 a[124:125], v235 offset:32768
    v_cvt_pk_bf16_f32 v176, v176, v177
    v_mfma_f32_16x16x32_bf16 a[156:159], a[144:147], v[184:187], a[156:159]
    v_exp_f32 v178, v178
    v_mfma_f32_16x16x32_bf16 a[160:163], a[144:147], v[192:195], a[160:163]
    ds_read_b64_tr_b16 a[126:127], v235 offset:36864
    v_mfma_f32_16x16x32_bf16 v[200:203], a[80:83], a[64:67], v[224:227]
    v_exp_f32 v179, v179
    v_mfma_f32_16x16x32_bf16 v[200:203], a[84:87], a[68:71], v[200:203]
    ds_read_b64_tr_b16 a[128:129], v236 offset:32768
    v_cvt_pk_bf16_f32 v177, v178, v179
    v_mfma_f32_16x16x32_bf16 v[200:203], a[88:91], a[72:75], v[200:203]
    v_exp_f32 v180, v180
    v_mfma_f32_16x16x32_bf16 v[200:203], a[92:95], a[76:79], v[200:203]
    ds_read_b64_tr_b16 a[130:131], v236 offset:36864
    v_mfma_f32_16x16x32_bf16 v[204:207], a[96:99], a[64:67], v[224:227]
    v_exp_f32 v181, v181
    v_mfma_f32_16x16x32_bf16 v[204:207], a[100:103], a[68:71], v[204:207]
    ds_read_b64_tr_b16 a[132:133], v237 offset:32768
    v_cvt_pk_bf16_f32 v178, v180, v181
    v_mfma_f32_16x16x32_bf16 v[204:207], a[104:107], a[72:75], v[204:207]
    v_exp_f32 v182, v182
    v_mfma_f32_16x16x32_bf16 v[204:207], a[108:111], a[76:79], v[204:207]
    ds_read_b64_tr_b16 a[134:135], v237 offset:36864
    v_mfma_f32_16x16x32_bf16 v[184:187], a[80:83], a[32:35], v[216:219]
    v_exp_f32 v183, v183
    v_mfma_f32_16x16x32_bf16 v[184:187], a[84:87], a[36:39], v[184:187]
    v_cvt_pk_bf16_f32 v179, v182, v183
    s_add_u32 m0, s30, 8192
    v_mfma_f32_16x16x32_bf16 v[184:187], a[88:91], a[40:43], v[184:187]
    buffer_load_dwordx4 v240, s[12:15], s32 offen nt lds
    ds_read_b64_tr_b16 a[136:137], v238 offset:32768
    v_mfma_f32_16x16x32_bf16 v[184:187], a[92:95], a[44:47], v[184:187]
    v_exp_f32 v200, v200
    v_mfma_f32_16x16x32_bf16 v[188:191], a[96:99], a[32:35], v[216:219]
    buffer_load_dwordx4 v241, s[12:15], s32 offen offset:1024 nt lds
    ds_read_b64_tr_b16 a[138:139], v238 offset:36864
    v_mfma_f32_16x16x32_bf16 v[188:191], a[100:103], a[36:39], v[188:191]
    v_exp_f32 v201, v201
    v_mfma_f32_16x16x32_bf16 v[188:191], a[104:107], a[40:43], v[188:191]
    ds_read_b64_tr_b16 a[140:141], v239 offset:32768
    v_cvt_pk_bf16_f32 v200, v200, v201
    v_mfma_f32_16x16x32_bf16 v[188:191], a[108:111], a[44:47], v[188:191]
    v_exp_f32 v202, v202
    v_mfma_f32_16x16x32_bf16 v[192:195], a[80:83], a[48:51], v[220:223]
    ds_read_b64_tr_b16 a[142:143], v239 offset:36864
    v_mfma_f32_16x16x32_bf16 v[192:195], a[84:87], a[52:55], v[192:195]
    v_exp_f32 v203, v203
    v_mfma_f32_16x16x32_bf16 v[192:195], a[88:91], a[56:59], v[192:195]
    ds_read_b128 a[80:83], v228 offset:40960
    v_cvt_pk_bf16_f32 v201, v202, v203
    v_mfma_f32_16x16x32_bf16 v[192:195], a[92:95], a[60:63], v[192:195]
    v_exp_f32 v184, v184
    v_mfma_f32_16x16x32_bf16 v[196:199], a[96:99], a[48:51], v[220:223]
    ds_read_b128 a[84:87], v229 offset:40960
    v_mfma_f32_16x16x32_bf16 v[196:199], a[100:103], a[52:55], v[196:199]
    v_exp_f32 v185, v185
    v_mfma_f32_16x16x32_bf16 v[196:199], a[104:107], a[56:59], v[196:199]
    v_cvt_pk_bf16_f32 v184, v184, v185
    v_mfma_f32_16x16x32_bf16 v[196:199], a[108:111], a[60:63], v[196:199]
    ds_read_b128 a[88:91], v230 offset:40960
    s_waitcnt lgkmcnt(3)
    v_mfma_f32_16x16x32_bf16 v[8:11], a[112:115], v[168:171], v[8:11]
    v_exp_f32 v186, v186
    v_mfma_f32_16x16x32_bf16 v[12:15], a[116:119], v[168:171], v[12:15]
    ds_read_b128 a[92:95], v231 offset:40960
    v_mfma_f32_16x16x32_bf16 v[16:19], a[120:123], v[168:171], v[16:19]
    v_exp_f32 v187, v187
    v_mfma_f32_16x16x32_bf16 v[20:23], a[124:127], v[168:171], v[20:23]
    ds_read_b128 a[96:99], v228 offset:45056
    v_cvt_pk_bf16_f32 v185, v186, v187
    v_mfma_f32_16x16x32_bf16 v[24:27], a[128:131], v[168:171], v[24:27]
    v_exp_f32 v188, v188
    v_mfma_f32_16x16x32_bf16 v[28:31], a[132:135], v[168:171], v[28:31]
    ds_read_b128 a[100:103], v229 offset:45056
    v_mfma_f32_16x16x32_bf16 v[32:35], a[136:139], v[168:171], v[32:35]
    v_exp_f32 v189, v189
    v_mfma_f32_16x16x32_bf16 v[36:39], a[140:143], v[168:171], v[36:39]
    ds_read_b128 a[104:107], v230 offset:45056
    v_cvt_pk_bf16_f32 v186, v188, v189
    v_mfma_f32_16x16x32_bf16 a[148:151], a[144:147], v[168:171], a[148:151]
    v_exp_f32 v190, v190
    v_mfma_f32_16x16x32_bf16 v[40:43], a[112:115], v[176:179], v[40:43]
    ds_read_b128 a[108:111], v231 offset:45056
    v_mfma_f32_16x16x32_bf16 v[44:47], a[116:119], v[176:179], v[44:47]
    v_exp_f32 v191, v191
    v_mfma_f32_16x16x32_bf16 v[48:51], a[120:123], v[176:179], v[48:51]
    v_cvt_pk_bf16_f32 v187, v190, v191
    v_mfma_f32_16x16x32_bf16 v[52:55], a[124:127], v[176:179], v[52:55]
    v_exp_f32 v204, v204
    v_mfma_f32_16x16x32_bf16 v[56:59], a[128:131], v[176:179], v[56:59]
    s_cmp_lt_u32 s49, 90112
    s_cbranch_scc1 L_pf0_1_2
L_pf0_1_2r:
    v_mfma_f32_16x16x32_bf16 v[60:63], a[132:135], v[176:179], v[60:63]
    v_exp_f32 v205, v205
    v_mfma_f32_16x16x32_bf16 v[64:67], a[136:139], v[176:179], v[64:67]
    v_cvt_pk_bf16_f32 v202, v204, v205
    v_mfma_f32_16x16x32_bf16 v[68:71], a[140:143], v[176:179], v[68:71]
    v_exp_f32 v206, v206
    v_mfma_f32_16x16x32_bf16 a[152:155], a[144:147], v[176:179], a[152:155]
    s_waitcnt lgkmcnt(0)
    v_mfma_f32_16x16x32_bf16 v[168:171], a[80:83], a[0:3], v[208:211]
    v_exp_f32 v207, v207
    v_mfma_f32_16x16x32_bf16 v[168:171], a[84:87], a[4:7], v[168:171]
    v_cvt_pk_bf16_f32 v203, v206, v207
    v_mfma_f32_16x16x32_bf16 v[168:171], a[88:91], a[8:11], v[168:171]
    v_mfma_f32_16x16x32_bf16 v[168:171], a[92:95], a[12:15], v[168:171]
    v_exp_f32 v192, v192
    v_mfma_f32_16x16x32_bf16 v[172:175], a[96:99], a[0:3], v[208:211]
    v_mfma_f32_16x16x32_bf16 v[172:175], a[100:103], a[4:7], v[172:175]
    v_exp_f32 v193, v193
    v_mfma_f32_16x16x32_bf16 v[172:175], a[104:107], a[8:11], v[172:175]
    v_cvt_pk_bf16_f32 v192, v192, v193
    s_add_u32 m0, s30, 73728
    v_mfma_f32_16x16x32_bf16 v[172:175], a[108:111], a[12:15], v[172:175]
    v_exp_f32 v194, v194
    v_mfma_f32_16x16x32_bf16 v[176:179], a[80:83], a[16:19], v[212:215]
    buffer_load_dwordx4 v242, s[16:19], s32 offen nt lds
    v_mfma_f32_16x16x32_bf16 v[176:179], a[84:87], a[20:23], v[176:179]
    v_exp_f32 v195, v195
    v_mfma_f32_16x16x32_bf16 v[176:179], a[88:91], a[24:27], v[176:179]
    buffer_load_dwordx4 v243, s[16:19], s32 offen offset:1024 nt lds
    v_cvt_pk_bf16_f32 v193, v194, v195
    v_mfma_f32_16x16x32_bf16 v[176:179], a[92:95], a[28:31], v[176:179]
    v_exp_f32 v196, v196
    v_mfma_f32_16x16x32_bf16 v[180:183], a[96:99], a[16:19], v[212:215]
    s_add_u32 s32, s32, 16384
    v_mfma_f32_16x16x32_bf16 v[180:183], a[100:103], a[20:23], v[180:183]
    v_exp_f32 v197, v197
    v_mfma_f32_16x16x32_bf16 v[180:183], a[104:107], a[24:27], v[180:183]
    v_cvt_pk_bf16_f32 v194, v196, v197
    v_mfma_f32_16x16x32_bf16 v[180:183], a[108:111], a[28:31], v[180:183]
    v_exp_f32 v198, v198
    v_mfma_f32_16x16x32_bf16 v[136:139], a[112:115], v[200:203], v[136:139]
    v_mfma_f32_16x16x32_bf16 v[140:143], a[116:119], v[200:203], v[140:143]
    v_exp_f32 v199, v199
    v_mfma_f32_16x16x32_bf16 v[144:147], a[120:123], v[200:203], v[144:147]
    v_cvt_pk_bf16_f32 v195, v198, v199
    v_mfma_f32_16x16x32_bf16 v[148:151], a[124:127], v[200:203], v[148:151]
    v_mfma_f32_16x16x32_bf16 v[152:155], a[128:131], v[200:203], v[152:155]
    v_exp_f32 v168, v168
    v_mfma_f32_16x16x32_bf16 v[156:159], a[132:135], v[200:203], v[156:159]
    s_cmp_lt_u32 s49, 90112
    s_cbranch_scc1 L_pf0_2_2
L_pf0_2_2r:
    v_mfma_f32_16x16x32_bf16 v[160:163], a[136:139], v[200:203], v[160:163]
    v_exp_f32 v169, v169
    v_mfma_f32_16x16x32_bf16 v[164:167], a[140:143], v[200:203], v[164:167]
    v_cvt_pk_bf16_f32 v168, v168, v169
    v_mfma_f32_16x16x32_bf16 a[164:167], a[144:147], v[200:203], a[164:167]
    v_exp_f32 v170, v170
    v_mfma_f32_16x16x32_bf16 v[72:75], a[112:115], v[184:187], v[72:75]
    v_mfma_f32_16x16x32_bf16 v[104:107], a[112:115], v[192:195], v[104:107]
    v_exp_f32 v171, v171
    v_mfma_f32_16x16x32_bf16 v[76:79], a[116:119], v[184:187], v[76:79]
    ds_read_b64_tr_b16 a[112:113], v232 offset:40960
    v_cvt_pk_bf16_f32 v169, v170, v171
    v_mfma_f32_16x16x32_bf16 v[108:111], a[116:119], v[192:195], v[108:111]
    v_exp_f32 v172, v172
    v_mfma_f32_16x16x32_bf16 v[80:83], a[120:123], v[184:187], v[80:83]
    ds_read_b64_tr_b16 a[114:115], v232 offset:45056
    v_mfma_f32_16x16x32_bf16 v[112:115], a[120:123], v[192:195], v[112:115]
    v_exp_f32 v173, v173
    v_mfma_f32_16x16x32_bf16 v[84:87], a[124:127], v[184:187], v[84:87]
    ds_read_b64_tr_b16 a[116:117], v233 offset:40960
    v_cvt_pk_bf16_f32 v170, v172, v173
    v_mfma_f32_16x16x32_bf16 v[116:119], a[124:127], v[192:195], v[116:119]
    v_exp_f32 v174, v174
    v_mfma_f32_16x16x32_bf16 v[88:91], a[128:131], v[184:187], v[88:91]
    ds_read_b64_tr_b16 a[118:119], v233 offset:45056
    ds_read_b64_tr_b16 a[120:121], v234 offset:40960
    v_mfma_f32_16x16x32_bf16 v[120:123], a[128:131], v[192:195], v[120:123]
    v_exp_f32 v175, v175
    v_mfma_f32_16x16x32_bf16 v[92:95], a[132:135], v[184:187], v[92:95]
    ds_read_b64_tr_b16 a[122:123], v234 offset:45056
    v_cvt_pk_bf16_f32 v171, v174, v175
    v_mfma_f32_16x16x32_bf16 v[124:127], a[132:135], v[192:195], v[124:127]
    ds_read_b64_tr_b16 a[124:125], v235 offset:40960
    ds_read_b64_tr_b16 a[126:127], v235 offset:45056
    v_mfma_f32_16x16x32_bf16 v[96:99], a[136:139], v[184:187], v[96:99]
    v_exp_f32 v176, v176
    v_mfma_f32_16x16x32_bf16 v[128:131], a[136:139], v[192:195], v[128:131]
    ds_read_b64_tr_b16 a[128:129], v236 offset:40960
    ds_read_b64_tr_b16 a[130:131], v236 offset:45056
    v_mfma_f32_16x16x32_bf16 v[100:103], a[140:143], v[184:187], v[100:103]
    v_exp_f32 v177, v177
    v_mfma_f32_16x16x32_bf16 v[132:135], a[140:143], v[192:195], v[132:135]
    ds_read_b64_tr_b16 a[132:133], v237 offset:40960
    v_cvt_pk_bf16_f32 v176, v176, v177
    v_mfma_f32_16x16x32_bf16 a[156:159], a[144:147], v[184:187], a[156:159]
    v_exp_f32 v178, v178
    v_mfma_f32_16x16x32_bf16 a[160:163], a[144:147], v[192:195], a[160:163]
    ds_read_b64_tr_b16 a[134:135], v237 offset:45056
    ds_read_b64_tr_b16 a[136:137], v238 offset:40960
    v_mfma_f32_16x16x32_bf16 v[184:187], a[80:83], a[32:35], v[216:219]
    v_exp_f32 v179, v179
    v_mfma_f32_16x16x32_bf16 v[184:187], a[84:87], a[36:39], v[184:187]
    v_cvt_pk_bf16_f32 v177, v178, v179
    s_add_u32 m0, s30, 16384
    v_mfma_f32_16x16x32_bf16 v[184:187], a[88:91], a[40:43], v[184:187]
    v_exp_f32 v180, v180
    v_mfma_f32_16x16x32_bf16 v[184:187], a[92:95], a[44:47], v[184:187]
    buffer_load_dwordx4 v240, s[12:15], s31 offen nt lds
    ds_read_b64_tr_b16 a[138:139], v238 offset:45056
    v_mfma_f32_16x16x32_bf16 v[188:191], a[96:99], a[32:35], v[216:219]
    v_exp_f32 v181, v181
    v_mfma_f32_16x16x32_bf16 v[188:191], a[100:103], a[36:39], v[188:191]
    buffer_load_dwordx4 v241, s[12:15], s31 offen offset:1024 nt lds
    v_cvt_pk_bf16_f32 v178, v180, v181
    v_mfma_f32_16x16x32_bf16 v[188:191], a[104:107], a[40:43], v[188:191]
    v_exp_f32 v182, v182
    v_mfma_f32_16x16x32_bf16 v[188:191], a[108:111], a[44:47], v[188:191]
    ds_read_b64_tr_b16 a[140:141], v239 offset:40960
    ds_read_b64_tr_b16 a[142:143], v239 offset:45056
    v_mfma_f32_16x16x32_bf16 v[192:195], a[80:83], a[48:51], v[220:223]
    v_exp_f32 v183, v183
    v_mfma_f32_16x16x32_bf16 v[192:195], a[84:87], a[52:55], v[192:195]
    v_cvt_pk_bf16_f32 v179, v182, v183
    v_mfma_f32_16x16x32_bf16 v[192:195], a[88:91], a[56:59], v[192:195]
    ds_read_b128 a[80:83], v228 offset:49152
    v_mfma_f32_16x16x32_bf16 v[192:195], a[92:95], a[60:63], v[192:195]
    v_exp_f32 v184, v184
    v_mfma_f32_16x16x32_bf16 v[196:199], a[96:99], a[48:51], v[220:223]
    ds_read_b128 a[84:87], v229 offset:49152
    v_mfma_f32_16x16x32_bf16 v[196:199], a[100:103], a[52:55], v[196:199]
    v_exp_f32 v185, v185
    v_mfma_f32_16x16x32_bf16 v[196:199], a[104:107], a[56:59], v[196:199]
    v_cvt_pk_bf16_f32 v184, v184, v185
    v_mfma_f32_16x16x32_bf16 v[196:199], a[108:111], a[60:63], v[196:199]
    ds_read_b128 a[88:91], v230 offset:49152
    s_waitcnt lgkmcnt(3)
    v_mfma_f32_16x16x32_bf16 v[8:11], a[112:115], v[168:171], v[8:11]
    v_exp_f32 v186, v186
    v_mfma_f32_16x16x32_bf16 v[12:15], a[116:119], v[168:171], v[12:15]
    ds_read_b128 a[92:95], v231 offset:49152
    v_mfma_f32_16x16x32_bf16 v[16:19], a[120:123], v[168:171], v[16:19]
    v_exp_f32 v187, v187
    v_mfma_f32_16x16x32_bf16 v[20:23], a[124:127], v[168:171], v[20:23]
    ds_read_b128 a[96:99], v228 offset:53248
    v_cvt_pk_bf16_f32 v185, v186, v187
    v_mfma_f32_16x16x32_bf16 v[24:27], a[128:131], v[168:171], v[24:27]
    v_exp_f32 v188, v188
    v_mfma_f32_16x16x32_bf16 v[28:31], a[132:135], v[168:171], v[28:31]
    ds_read_b128 a[100:103], v229 offset:53248
    v_mfma_f32_16x16x32_bf16 v[32:35], a[136:139], v[168:171], v[32:35]
    v_exp_f32 v189, v189
    v_mfma_f32_16x16x32_bf16 v[36:39], a[140:143], v[168:171], v[36:39]
    ds_read_b128 a[104:107], v230 offset:53248
    v_cvt_pk_bf16_f32 v186, v188, v189
    v_mfma_f32_16x16x32_bf16 a[148:151], a[144:147], v[168:171], a[148:151]
    v_exp_f32 v190, v190
    v_mfma_f32_16x16x32_bf16 v[40:43], a[112:115], v[176:179], v[40:43]
    ds_read_b128 a[108:111], v231 offset:53248
    v_mfma_f32_16x16x32_bf16 v[44:47], a[116:119], v[176:179], v[44:47]
    v_exp_f32 v191, v191
    v_mfma_f32_16x16x32_bf16 v[48:51], a[120:123], v[176:179], v[48:51]
    v_cvt_pk_bf16_f32 v187, v190, v191
    v_mfma_f32_16x16x32_bf16 v[52:55], a[124:127], v[176:179], v[52:55]
    v_exp_f32 v192, v192
    v_mfma_f32_16x16x32_bf16 v[56:59], a[128:131], v[176:179], v[56:59]
    v_mfma_f32_16x16x32_bf16 v[60:63], a[132:135], v[176:179], v[60:63]
    v_exp_f32 v193, v193
    v_mfma_f32_16x16x32_bf16 v[64:67], a[136:139], v[176:179], v[64:67]
    v_cvt_pk_bf16_f32 v192, v192, v193
    v_mfma_f32_16x16x32_bf16 v[68:71], a[140:143], v[176:179], v[68:71]
    v_exp_f32 v194, v194
    v_mfma_f32_16x16x32_bf16 a[152:155], a[144:147], v[176:179], a[152:155]
    s_waitcnt lgkmcnt(0)
    v_mfma_f32_16x16x32_bf16 v[168:171], a[80:83], a[0:3], v[208:211]
    s_waitcnt vmcnt(8)
    s_barrier
L_in0_3:
    v_mfma_f32_16x16x32_bf16 v[168:171], a[84:87], a[4:7], v[168:171]
    v_exp_f32 v195, v195
    v_mfma_f32_16x16x32_bf16 v[168:171], a[88:91], a[8:11], v[168:171]
    v_cvt_pk_bf16_f32 v193, v194, v195
    s_add_u32 m0, s30, 81920
    v_mfma_f32_16x16x32_bf16 v[168:171], a[92:95], a[12:15], v[168:171]
    v_exp_f32 v196, v196
    v_mfma_f32_16x16x32_bf16 v[172:175], a[96:99], a[0:3], v[208:211]
    buffer_load_dwordx4 v242, s[16:19], s31 offen nt lds
    v_mfma_f32_16x16x32_bf16 v[172:175], a[100:103], a[4:7], v[172:175]
    v_exp_f32 v197, v197
    v_mfma_f32_16x16x32_bf16 v[172:175], a[104:107], a[8:11], v[172:175]
    buffer_load_dwordx4 v243, s[16:19], s31 offen offset:1024 nt lds
    v_cvt_pk_bf16_f32 v194, v196, v197
    v_mfma_f32_16x16x32_bf16 v[172:175], a[108:111], a[12:15], v[172:175]
    v_exp_f32 v198, v198
    v_mfma_f32_16x16x32_bf16 v[176:179], a[80:83], a[16:19], v[212:215]
    s_add_u32 s31, s31, 16384
    v_mfma_f32_16x16x32_bf16 v[176:179], a[84:87], a[20:23], v[176:179]
    v_exp_f32 v199, v199
    v_mfma_f32_16x16x32_bf16 v[176:179], a[88:91], a[24:27], v[176:179]
    v_cvt_pk_bf16_f32 v195, v198, v199
    v_mfma_f32_16x16x32_bf16 v[176:179], a[92:95], a[28:31], v[176:179]
    v_exp_f32 v168, v168
    v_mfma_f32_16x16x32_bf16 v[180:183], a[96:99], a[16:19], v[212:215]
    s_cmp_lt_u32 s49, 90112
    s_cbranch_scc1 L_pf0_0_3
L_pf0_0_3r:
    v_mfma_f32_16x16x32_bf16 v[180:183], a[100:103], a[20:23], v[180:183]
    v_exp_f32 v169, v169
    v_mfma_f32_16x16x32_bf16 v[180:183], a[104:107], a[24:27], v[180:183]
    v_cvt_pk_bf16_f32 v168, v168, v169
    v_mfma_f32_16x16x32_bf16 v[180:183], a[108:111], a[28:31], v[180:183]
    v_exp_f32 v170, v170
    v_mfma_f32_16x16x32_bf16 v[72:75], a[112:115], v[184:187], v[72:75]
    v_mfma_f32_16x16x32_bf16 v[104:107], a[112:115], v[192:195], v[104:107]
    v_exp_f32 v171, v171
    v_mfma_f32_16x16x32_bf16 v[76:79], a[116:119], v[184:187], v[76:79]
    ds_read_b64_tr_b16 a[112:113], v232 offset:49152
    v_cvt_pk_bf16_f32 v169, v170, v171
    v_mfma_f32_16x16x32_bf16 v[108:111], a[116:119], v[192:195], v[108:111]
    v_exp_f32 v172, v172
    v_mfma_f32_16x16x32_bf16 v[80:83], a[120:123], v[184:187], v[80:83]
    ds_read_b64_tr_b16 a[114:115], v232 offset:53248
    v_mfma_f32_16x16x32_bf16 v[112:115], a[120:123], v[192:195], v[112:115]
    v_exp_f32 v173, v173
    v_mfma_f32_16x16x32_bf16 v[84:87], a[124:127], v[184:187], v[84:87]
    ds_read_b64_tr_b16 a[116:117], v233 offset:49152
    v_cvt_pk_bf16_f32 v170, v172, v173
    v_mfma_f32_16x16x32_bf16 v[116:119], a[124:127], v[192:195], v[116:119]
    v_exp_f32 v174, v174
    v_mfma_f32_16x16x32_bf16 v[88:91], a[128:131], v[184:187], v[88:91]
    ds_read_b64_tr_b16 a[118:119], v233 offset:53248
    v_mfma_f32_16x16x32_bf16 v[120:123], a[128:131], v[192:195], v[120:123]
    v_exp_f32 v175, v175
    v_mfma_f32_16x16x32_bf16 v[92:95], a[132:135], v[184:187], v[92:95]
    v_cvt_pk_bf16_f32 v171, v174, v175
    v_mfma_f32_16x16x32_bf16 v[124:127], a[132:135], v[192:195], v[124:127]
    ds_read_b64_tr_b16 a[120:121], v234 offset:49152
    v_mfma_f32_16x16x32_bf16 v[96:99], a[136:139], v[184:187], v[96:99]
    v_exp_f32 v176, v176
    v_mfma_f32_16x16x32_bf16 v[128:131], a[136:139], v[192:195], v[128:131]
    ds_read_b64_tr_b16 a[122:123], v234 offset:53248
    v_mfma_f32_16x16x32_bf16 v[100:103], a[140:143], v[184:187], v[100:103]
    v_exp_f32 v177, v177
    v_mfma_f32_16x16x32_bf16 v[132:135], a[140:143], v[192:195], v[132:135]
    ds_read_b64_tr_b16 a[124:125], v235 offset:49152
    v_cvt_pk_bf16_f32 v176, v176, v177
    v_mfma_f32_16x16x32_bf16 a[156:159], a[144:147], v[184:187], a[156:159]
    v_exp_f32 v178, v178
    v_mfma_f32_16x16x32_bf16 a[160:163], a[144:147], v[192:195], a[160:163]
    ds_read_b64_tr_b16 a[126:127], v235 offset:53248
    v_mfma_f32_16x16x32_bf16 v[200:203], a[80:83], a[64:67], v[224:227]
    v_exp_f32 v179, v179
    v_mfma_f32_16x16x32_bf16 v[200:203], a[84:87], a[68:71], v[200:203]
    ds_read_b64_tr_b16 a[128:129], v236 offset:49152
    v_cvt_pk_bf16_f32 v177, v178, v179
    v_mfma_f32_16x16x32_bf16 v[200:203], a[88:91], a[72:75], v[200:203]
    v_exp_f32 v180, v180
    v_mfma_f32_16x16x32_bf16 v[200:203], a[92:95], a[76:79], v[200:203]
    ds_read_b64_tr_b16 a[130:131], v236 offset:53248
    v_mfma_f32_16x16x32_bf16 v[204:207], a[96:99], a[64:67], v[224:227]
    v_exp_f32 v181, v181
    v_mfma_f32_16x16x32_bf16 v[204:207], a[100:103], a[68:71], v[204:207]
    ds_read_b64_tr_b16 a[132:133], v237 offset:49152
    v_cvt_pk_bf16_f32 v178, v180, v181
    v_mfma_f32_16x16x32_bf16 v[204:207], a[104:107], a[72:75], v[204:207]
    v_exp_f32 v182, v182
    v_mfma_f32_16x16x32_bf16 v[204:207], a[108:111], a[76:79], v[204:207]
    ds_read_b64_tr_b16 a[134:135], v237 offset:53248
    v_mfma_f32_16x16x32_bf16 v[184:187], a[80:83], a[32:35], v[216:219]
    v_exp_f32 v183, v183
    v_mfma_f32_16x16x32_bf16 v[184:187], a[84:87], a[36:39], v[184:187]
    v_cvt_pk_bf16_f32 v179, v182, v183
    s_add_u32 m0, s30, 24576
    v_mfma_f32_16x16x32_bf16 v[184:187], a[88:91], a[40:43], v[184:187]
    buffer_load_dwordx4 v240, s[12:15], s32 offen nt lds
    ds_read_b64_tr_b16 a[136:137], v238 offset:49152
    v_mfma_f32_16x16x32_bf16 v[184:187], a[92:95], a[44:47], v[184:187]
    v_exp_f32 v200, v200
    v_mfma_f32_16x16x32_bf16 v[188:191], a[96:99], a[32:35], v[216:219]
    buffer_load_dwordx4 v241, s[12:15], s32 offen offset:1024 nt lds
    ds_read_b64_tr_b16 a[138:139], v238 offset:53248
    v_mfma_f32_16x16x32_bf16 v[188:191], a[100:103], a[36:39], v[188:191]
    v_exp_f32 v201, v201
    v_mfma_f32_16x16x32_bf16 v[188:191], a[104:107], a[40:43], v[188:191]
    ds_read_b64_tr_b16 a[140:141], v239 offset:49152
    v_cvt_pk_bf16_f32 v200, v200, v201
    v_mfma_f32_16x16x32_bf16 v[188:191], a[108:111], a[44:47], v[188:191]
    v_exp_f32 v202, v202
    v_mfma_f32_16x16x32_bf16 v[192:195], a[80:83], a[48:51], v[220:223]
    ds_read_b64_tr_b16 a[142:143], v239 offset:53248
    v_mfma_f32_16x16x32_bf16 v[192:195], a[84:87], a[52:55], v[192:195]
    v_exp_f32 v203, v203
    v_mfma_f32_16x16x32_bf16 v[192:195], a[88:91], a[56:59], v[192:195]
    ds_read_b128 a[80:83], v228 offset:57344
    v_cvt_pk_bf16_f32 v201, v202, v203
    v_mfma_f32_16x16x32_bf16 v[192:195], a[92:95], a[60:63], v[192:195]
    v_exp_f32 v184, v184
    v_mfma_f32_16x16x32_bf16 v[196:199], a[96:99], a[48:51], v[220:223]
    ds_read_b128 a[84:87], v229 offset:57344
    v_mfma_f32_16x16x32_bf16 v[196:199], a[100:103], a[52:55], v[196:199]
    v_exp_f32 v185, v185
    v_mfma_f32_16x16x32_bf16 v[196:199], a[104:107], a[56:59], v[196:199]
    v_cvt_pk_bf16_f32 v184, v184, v185
    v_mfma_f32_16x16x32_bf16 v[196:199], a[108:111], a[60:63], v[196:199]
    ds_read_b128 a[88:91], v230 offset:57344
    s_waitcnt lgkmcnt(3)
    v_mfma_f32_16x16x32_bf16 v[8:11], a[112:115], v[168:171], v[8:11]
    v_exp_f32 v186, v186
    v_mfma_f32_16x16x32_bf16 v[12:15], a[116:119], v[168:171], v[12:15]
    ds_read_b128 a[92:95], v231 offset:57344
    v_mfma_f32_16x16x32_bf16 v[16:19], a[120:123], v[168:171], v[16:19]
    v_exp_f32 v187, v187
    v_mfma_f32_16x16x32_bf16 v[20:23], a[124:127], v[168:171], v[20:23]
    ds_read_b128 a[96:99], v228 offset:61440
    v_cvt_pk_bf16_f32 v185, v186, v187
    v_mfma_f32_16x16x32_bf16 v[24:27], a[128:131], v[168:171], v[24:27]
    v_exp_f32 v188, v188
    v_mfma_f32_16x16x32_bf16 v[28:31], a[132:135], v[168:171], v[28:31]
    ds_read_b128 a[100:103], v229 offset:61440
    v_mfma_f32_16x16x32_bf16 v[32:35], a[136:139], v[168:171], v[32:35]
    v_exp_f32 v189, v189
    v_mfma_f32_16x16x32_bf16 v[36:39], a[140:143], v[168:171], v[36:39]
    ds_read_b128 a[104:107], v230 offset:61440
    v_cvt_pk_bf16_f32 v186, v188, v189
    v_mfma_f32_16x16x32_bf16 a[148:151], a[144:147], v[168:171], a[148:151]
    v_exp_f32 v190, v190
    v_mfma_f32_16x16x32_bf16 v[40:43], a[112:115], v[176:179], v[40:43]
    ds_read_b128 a[108:111], v231 offset:61440
    v_mfma_f32_16x16x32_bf16 v[44:47], a[116:119], v[176:179], v[44:47]
    v_exp_f32 v191, v191
    v_mfma_f32_16x16x32_bf16 v[48:51], a[120:123], v[176:179], v[48:51]
    v_cvt_pk_bf16_f32 v187, v190, v191
    v_mfma_f32_16x16x32_bf16 v[52:55], a[124:127], v[176:179], v[52:55]
    v_exp_f32 v204, v204
    v_mfma_f32_16x16x32_bf16 v[56:59], a[128:131], v[176:179], v[56:59]
    s_cmp_lt_u32 s49, 90112
    s_cbranch_scc1 L_pf0_1_3
L_pf0_1_3r:
    v_mfma_f32_16x16x32_bf16 v[60:63], a[132:135], v[176:179], v[60:63]
    v_exp_f32 v205, v205
    v_mfma_f32_16x16x32_bf16 v[64:67], a[136:139], v[176:179], v[64:67]
    v_cvt_pk_bf16_f32 v202, v204, v205
    v_mfma_f32_16x16x32_bf16 v[68:71], a[140:143], v[176:179], v[68:71]
    v_exp_f32 v206, v206
    v_mfma_f32_16x16x32_bf16 a[152:155], a[144:147], v[176:179], a[152:155]
    s_waitcnt lgkmcnt(0)
    v_mfma_f32_16x16x32_bf16 v[168:171], a[80:83], a[0:3], v[208:211]
    v_exp_f32 v207, v207
    v_mfma_f32_16x16x32_bf16 v[168:171], a[84:87], a[4:7], v[168:171]
    v_cvt_pk_bf16_f32 v203, v206, v207
    v_mfma_f32_16x16x32_bf16 v[168:171], a[88:91], a[8:11], v[168:171]
    v_mfma_f32_16x16x32_bf16 v[168:171], a[92:95], a[12:15], v[168:171]
    v_exp_f32 v192, v192
    v_mfma_f32_16x16x32_bf16 v[172:175], a[96:99], a[0:3], v[208:211]
    v_mfma_f32_16x16x32_bf16 v[172:175], a[100:103], a[4:7], v[172:175]
    v_exp_f32 v193, v193
    v_mfma_f32_16x16x32_bf16 v[172:175], a[104:107], a[8:11], v[172:175]
    v_cvt_pk_bf16_f32 v192, v192, v193
    s_add_u32 m0, s30, 90112
    v_mfma_f32_16x16x32_bf16 v[172:175], a[108:111], a[12:15], v[172:175]
    v_exp_f32 v194, v194
    v_mfma_f32_16x16x32_bf16 v[176:179], a[80:83], a[16:19], v[212:215]
    buffer_load_dwordx4 v242, s[16:19], s32 offen nt lds
    v_mfma_f32_16x16x32_bf16 v[176:179], a[84:87], a[20:23], v[176:179]
    v_exp_f32 v195, v195
    v_mfma_f32_16x16x32_bf16 v[176:179], a[88:91], a[24:27], v[176:179]
    buffer_load_dwordx4 v243, s[16:19], s32 offen offset:1024 nt lds
    v_cvt_pk_bf16_f32 v193, v194, v195
    v_mfma_f32_16x16x32_bf16 v[176:179], a[92:95], a[28:31], v[176:179]
    v_exp_f32 v196, v196
    v_mfma_f32_16x16x32_bf16 v[180:183], a[96:99], a[16:19], v[212:215]
    s_add_u32 s32, s32, 16384
    v_mfma_f32_16x16x32_bf16 v[180:183], a[100:103], a[20:23], v[180:183]
    v_exp_f32 v197, v197
    v_mfma_f32_16x16x32_bf16 v[180:183], a[104:107], a[24:27], v[180:183]
    v_cvt_pk_bf16_f32 v194, v196, v197
    v_mfma_f32_16x16x32_bf16 v[180:183], a[108:111], a[28:31], v[180:183]
    v_exp_f32 v198, v198
    v_mfma_f32_16x16x32_bf16 v[136:139], a[112:115], v[200:203], v[136:139]
    v_mfma_f32_16x16x32_bf16 v[140:143], a[116:119], v[200:203], v[140:143]
    v_exp_f32 v199, v199
    v_mfma_f32_16x16x32_bf16 v[144:147], a[120:123], v[200:203], v[144:147]
    v_cvt_pk_bf16_f32 v195, v198, v199
    v_mfma_f32_16x16x32_bf16 v[148:151], a[124:127], v[200:203], v[148:151]
    v_mfma_f32_16x16x32_bf16 v[152:155], a[128:131], v[200:203], v[152:155]
    v_exp_f32 v168, v168
    v_mfma_f32_16x16x32_bf16 v[156:159], a[132:135], v[200:203], v[156:159]
    s_cmp_lt_u32 s49, 90112
    s_cbranch_scc1 L_pf0_2_3
L_pf0_2_3r:
    v_mfma_f32_16x16x32_bf16 v[160:163], a[136:139], v[200:203], v[160:163]
    v_exp_f32 v169, v169
    v_mfma_f32_16x16x32_bf16 v[164:167], a[140:143], v[200:203], v[164:167]
    v_cvt_pk_bf16_f32 v168, v168, v169
    v_mfma_f32_16x16x32_bf16 a[164:167], a[144:147], v[200:203], a[164:167]
    v_exp_f32 v170, v170
    v_mfma_f32_16x16x32_bf16 v[72:75], a[112:115], v[184:187], v[72:75]
    v_mfma_f32_16x16x32_bf16 v[104:107], a[112:115], v[192:195], v[104:107]
    v_exp_f32 v171, v171
    v_mfma_f32_16x16x32_bf16 v[76:79], a[116:119], v[184:187], v[76:79]
    ds_read_b64_tr_b16 a[112:113], v232 offset:57344
    v_cvt_pk_bf16_f32 v169, v170, v171
    v_mfma_f32_16x16x32_bf16 v[108:111], a[116:119], v[192:195], v[108:111]
    v_exp_f32 v172, v172
    v_mfma_f32_16x16x32_bf16 v[80:83], a[120:123], v[184:187], v[80:83]
    ds_read_b64_tr_b16 a[114:115], v232 offset:61440
    v_mfma_f32_16x16x32_bf16 v[112:115], a[120:123], v[192:195], v[112:115]
    v_exp_f32 v173, v173
    v_mfma_f32_16x16x32_bf16 v[84:87], a[124:127], v[184:187], v[84:87]
    ds_read_b64_tr_b16 a[116:117], v233 offset:57344
    v_cvt_pk_bf16_f32 v170, v172, v173
    v_mfma_f32_16x16x32_bf16 v[116:119], a[124:127], v[192:195], v[116:119]
    v_exp_f32 v174, v174
    v_mfma_f32_16x16x32_bf16 v[88:91], a[128:131], v[184:187], v[88:91]
    ds_read_b64_tr_b16 a[118:119], v233 offset:61440
    ds_read_b64_tr_b16 a[120:121], v234 offset:57344
    v_mfma_f32_16x16x32_bf16 v[120:123], a[128:131], v[192:195], v[120:123]
    v_exp_f32 v175, v175
    v_mfma_f32_16x16x32_bf16 v[92:95], a[132:135], v[184:187], v[92:95]
    ds_read_b64_tr_b16 a[122:123], v234 offset:61440
    v_cvt_pk_bf16_f32 v171, v174, v175
    v_mfma_f32_16x16x32_bf16 v[124:127], a[132:135], v[192:195], v[124:127]
    ds_read_b64_tr_b16 a[124:125], v235 offset:57344
    ds_read_b64_tr_b16 a[126:127], v235 offset:61440
    v_mfma_f32_16x16x32_bf16 v[96:99], a[136:139], v[184:187], v[96:99]
    v_exp_f32 v176, v176
    v_mfma_f32_16x16x32_bf16 v[128:131], a[136:139], v[192:195], v[128:131]
    ds_read_b64_tr_b16 a[128:129], v236 offset:57344
    ds_read_b64_tr_b16 a[130:131], v236 offset:61440
    v_mfma_f32_16x16x32_bf16 v[100:103], a[140:143], v[184:187], v[100:103]
    v_exp_f32 v177, v177
    v_mfma_f32_16x16x32_bf16 v[132:135], a[140:143], v[192:195], v[132:135]
    ds_read_b64_tr_b16 a[132:133], v237 offset:57344
    v_cvt_pk_bf16_f32 v176, v176, v177
    v_mfma_f32_16x16x32_bf16 a[156:159], a[144:147], v[184:187], a[156:159]
    v_exp_f32 v178, v178
    v_mfma_f32_16x16x32_bf16 a[160:163], a[144:147], v[192:195], a[160:163]
    ds_read_b64_tr_b16 a[134:135], v237 offset:61440
    ds_read_b64_tr_b16 a[136:137], v238 offset:57344
    v_mfma_f32_16x16x32_bf16 v[184:187], a[80:83], a[32:35], v[216:219]
    v_exp_f32 v179, v179
    v_mfma_f32_16x16x32_bf16 v[184:187], a[84:87], a[36:39], v[184:187]
    v_cvt_pk_bf16_f32 v177, v178, v179
    s_add_u32 m0, s30, 32768
    v_mfma_f32_16x16x32_bf16 v[184:187], a[88:91], a[40:43], v[184:187]
    v_exp_f32 v180, v180
    v_mfma_f32_16x16x32_bf16 v[184:187], a[92:95], a[44:47], v[184:187]
    buffer_load_dwordx4 v240, s[12:15], s31 offen nt lds
    ds_read_b64_tr_b16 a[138:139], v238 offset:61440
    v_mfma_f32_16x16x32_bf16 v[188:191], a[96:99], a[32:35], v[216:219]
    v_exp_f32 v181, v181
    v_mfma_f32_16x16x32_bf16 v[188:191], a[100:103], a[36:39], v[188:191]
    buffer_load_dwordx4 v241, s[12:15], s31 offen offset:1024 nt lds
    v_cvt_pk_bf16_f32 v178, v180, v181
    v_mfma_f32_16x16x32_bf16 v[188:191], a[104:107], a[40:43], v[188:191]
    v_exp_f32 v182, v182
    v_mfma_f32_16x16x32_bf16 v[188:191], a[108:111], a[44:47], v[188:191]
    ds_read_b64_tr_b16 a[140:141], v239 offset:57344
    ds_read_b64_tr_b16 a[142:143], v239 offset:61440
    v_mfma_f32_16x16x32_bf16 v[192:195], a[80:83], a[48:51], v[220:223]
    v_exp_f32 v183, v183
    v_mfma_f32_16x16x32_bf16 v[192:195], a[84:87], a[52:55], v[192:195]
    v_cvt_pk_bf16_f32 v179, v182, v183
    v_mfma_f32_16x16x32_bf16 v[192:195], a[88:91], a[56:59], v[192:195]
    ds_read_b128 a[80:83], v228 offset:0
    v_mfma_f32_16x16x32_bf16 v[192:195], a[92:95], a[60:63], v[192:195]
    v_exp_f32 v184, v184
    v_mfma_f32_16x16x32_bf16 v[196:199], a[96:99], a[48:51], v[220:223]
    ds_read_b128 a[84:87], v229 offset:0
    v_mfma_f32_16x16x32_bf16 v[196:199], a[100:103], a[52:55], v[196:199]
    v_exp_f32 v185, v185
    v_mfma_f32_16x16x32_bf16 v[196:199], a[104:107], a[56:59], v[196:199]
    v_cvt_pk_bf16_f32 v184, v184, v185
    v_mfma_f32_16x16x32_bf16 v[196:199], a[108:111], a[60:63], v[196:199]
    ds_read_b128 a[88:91], v230 offset:0
    s_waitcnt lgkmcnt(3)
    v_mfma_f32_16x16x32_bf16 v[8:11], a[112:115], v[168:171], v[8:11]
    v_exp_f32 v186, v186
    v_mfma_f32_16x16x32_bf16 v[12:15], a[116:119], v[168:171], v[12:15]
    ds_read_b128 a[92:95], v231 offset:0
    v_mfma_f32_16x16x32_bf16 v[16:19], a[120:123], v[168:171], v[16:19]
    v_exp_f32 v187, v187
    v_mfma_f32_16x16x32_bf16 v[20:23], a[124:127], v[168:171], v[20:23]
    ds_read_b128 a[96:99], v228 offset:4096
    v_cvt_pk_bf16_f32 v185, v186, v187
    v_mfma_f32_16x16x32_bf16 v[24:27], a[128:131], v[168:171], v[24:27]
    v_exp_f32 v188, v188
    v_mfma_f32_16x16x32_bf16 v[28:31], a[132:135], v[168:171], v[28:31]
    ds_read_b128 a[100:103], v229 offset:4096
    v_mfma_f32_16x16x32_bf16 v[32:35], a[136:139], v[168:171], v[32:35]
    v_exp_f32 v189, v189
    v_mfma_f32_16x16x32_bf16 v[36:39], a[140:143], v[168:171], v[36:39]
    ds_read_b128 a[104:107], v230 offset:4096
    v_cvt_pk_bf16_f32 v186, v188, v189
    v_mfma_f32_16x16x32_bf16 a[148:151], a[144:147], v[168:171], a[148:151]
    v_exp_f32 v190, v190
    v_mfma_f32_16x16x32_bf16 v[40:43], a[112:115], v[176:179], v[40:43]
    ds_read_b128 a[108:111], v231 offset:4096
    v_mfma_f32_16x16x32_bf16 v[44:47], a[116:119], v[176:179], v[44:47]
    v_exp_f32 v191, v191
    v_mfma_f32_16x16x32_bf16 v[48:51], a[120:123], v[176:179], v[48:51]
    v_cvt_pk_bf16_f32 v187, v190, v191
    v_mfma_f32_16x16x32_bf16 v[52:55], a[124:127], v[176:179], v[52:55]
    v_exp_f32 v192, v192
    v_mfma_f32_16x16x32_bf16 v[56:59], a[128:131], v[176:179], v[56:59]
    v_mfma_f32_16x16x32_bf16 v[60:63], a[132:135], v[176:179], v[60:63]
    v_exp_f32 v193, v193
    v_mfma_f32_16x16x32_bf16 v[64:67], a[136:139], v[176:179], v[64:67]
    v_cvt_pk_bf16_f32 v192, v192, v193
    v_mfma_f32_16x16x32_bf16 v[68:71], a[140:143], v[176:179], v[68:71]
    v_exp_f32 v194, v194
    v_mfma_f32_16x16x32_bf16 a[152:155], a[144:147], v[176:179], a[152:155]
    s_cmp_lt_u32 s31, 557056
    s_cbranch_scc1 L_loop0
    v_accvgpr_read_b32 v208, a168
    v_accvgpr_read_b32 v209, a169
    v_exp_f32 v195, v195
    v_accvgpr_read_b32 v210, a170
    v_accvgpr_read_b32 v211, a171
    v_cvt_pk_bf16_f32 v193, v194, v195
    v_accvgpr_read_b32 v212, a172
    v_accvgpr_read_b32 v213, a173
    v_exp_f32 v196, v196
    v_accvgpr_read_b32 v214, a174
    v_accvgpr_read_b32 v215, a175
    v_exp_f32 v197, v197
    v_accvgpr_read_b32 v216, a176
    v_accvgpr_read_b32 v217, a177
    v_cvt_pk_bf16_f32 v194, v196, v197
    v_accvgpr_read_b32 v218, a178
    v_accvgpr_read_b32 v219, a179
    v_exp_f32 v198, v198
    v_mov_b32 v246, 0
    v_mov_b32 v247, 0
    v_exp_f32 v199, v199
    v_accvgpr_read_b32 v250, a148
    v_accvgpr_read_b32 v251, a152
    v_cvt_pk_bf16_f32 v195, v198, v199
    v_mov_b32 v224, v250
    v_mov_b32 v225, v251
    v_mfma_f32_16x16x32_bf16 v[72:75], a[112:115], v[184:187], v[72:75]
    s_nop 1
    v_permlane16_swap_b32 v250, v224
    v_mfma_f32_16x16x32_bf16 v[104:107], a[112:115], v[192:195], v[104:107]
    v_permlane16_swap_b32 v251, v225
    v_add_f32 v250, v250, v224
    v_mfma_f32_16x16x32_bf16 v[76:79], a[116:119], v[184:187], v[76:79]
    v_add_f32 v251, v251, v225
    v_mov_b32 v224, v250
    v_mfma_f32_16x16x32_bf16 v[108:111], a[116:119], v[192:195], v[108:111]
    v_mov_b32 v225, v251
    s_nop 1
    v_permlane32_swap_b32 v250, v224
    v_permlane32_swap_b32 v251, v225
    v_mfma_f32_16x16x32_bf16 v[80:83], a[120:123], v[184:187], v[80:83]
    v_add_f32 v250, v250, v224
    v_add_f32 v251, v251, v225
    v_mfma_f32_16x16x32_bf16 v[112:115], a[120:123], v[192:195], v[112:115]
    v_cmp_nle_f32 s[42:43], v250, s40
    v_rcp_f32 v248, v250
    s_nop 0
    v_mov_b32 v249, v248
    v_mfma_f32_16x16x32_bf16 v[84:87], a[124:127], v[184:187], v[84:87]
    v_pk_mul_f32 v[8:9], v[8:9], v[248:249]
    v_pk_mul_f32 v[10:11], v[10:11], v[248:249]
    v_mfma_f32_16x16x32_bf16 v[116:119], a[124:127], v[192:195], v[116:119]
    v_pk_mul_f32 v[12:13], v[12:13], v[248:249]
    v_pk_mul_f32 v[14:15], v[14:15], v[248:249]
    v_mfma_f32_16x16x32_bf16 v[88:91], a[128:131], v[184:187], v[88:91]
    v_cvt_pk_bf16_f32 v168, v8, v9
    v_cvt_pk_bf16_f32 v169, v10, v11
    v_mfma_f32_16x16x32_bf16 v[120:123], a[128:131], v[192:195], v[120:123]
    v_cvt_pk_bf16_f32 v170, v12, v13
    v_cvt_pk_bf16_f32 v171, v14, v15
    v_mfma_f32_16x16x32_bf16 v[92:95], a[132:135], v[184:187], v[92:95]
    v_pk_fma_f32 v[246:247], v[8:9], 0, v[246:247]
    v_pk_fma_f32 v[246:247], v[10:11], 0, v[246:247]
    v_mfma_f32_16x16x32_bf16 v[124:127], a[132:135], v[192:195], v[124:127]
    v_permlane16_swap_b32 v168, v170
    v_permlane16_swap_b32 v169, v171
    v_mfma_f32_16x16x32_bf16 v[96:99], a[136:139], v[184:187], v[96:99]
    v_pk_fma_f32 v[246:247], v[12:13], 0, v[246:247]
    v_pk_fma_f32 v[246:247], v[14:15], 0, v[246:247]
    v_mfma_f32_16x16x32_bf16 v[128:131], a[136:139], v[192:195], v[128:131]
    ds_write_b128 v208, v[168:171] offset:0
    v_pk_mul_f32 v[16:17], v[16:17], v[248:249]
    v_mfma_f32_16x16x32_bf16 v[100:103], a[140:143], v[184:187], v[100:103]
    v_pk_mul_f32 v[18:19], v[18:19], v[248:249]
    v_pk_mul_f32 v[20:21], v[20:21], v[248:249]
    v_mfma_f32_16x16x32_bf16 v[132:135], a[140:143], v[192:195], v[132:135]
    v_pk_mul_f32 v[22:23], v[22:23], v[248:249]
    v_cvt_pk_bf16_f32 v172, v16, v17
    v_mfma_f32_16x16x32_bf16 a[156:159], a[144:147], v[184:187], a[156:159]
    v_cvt_pk_bf16_f32 v173, v18, v19
    v_cvt_pk_bf16_f32 v174, v20, v21
    v_mfma_f32_16x16x32_bf16 a[160:163], a[144:147], v[192:195], a[160:163]
    v_cvt_pk_bf16_f32 v175, v22, v23
    v_pk_fma_f32 v[246:247], v[16:17], 0, v[246:247]
    v_pk_fma_f32 v[246:247], v[18:19], 0, v[246:247]
    v_permlane16_swap_b32 v172, v174
    v_permlane16_swap_b32 v173, v175
    v_pk_fma_f32 v[246:247], v[20:21], 0, v[246:247]
    v_pk_fma_f32 v[246:247], v[22:23], 0, v[246:247]
    ds_write_b128 v209, v[172:175] offset:0
    v_pk_mul_f32 v[24:25], v[24:25], v[248:249]
    v_pk_mul_f32 v[26:27], v[26:27], v[248:249]
    v_pk_mul_f32 v[28:29], v[28:29], v[248:249]
    v_pk_mul_f32 v[30:31], v[30:31], v[248:249]
    v_cvt_pk_bf16_f32 v176, v24, v25
    v_cvt_pk_bf16_f32 v177, v26, v27
    v_cvt_pk_bf16_f32 v178, v28, v29
    v_cvt_pk_bf16_f32 v179, v30, v31
    v_pk_fma_f32 v[246:247], v[24:25], 0, v[246:247]
    v_pk_fma_f32 v[246:247], v[26:27], 0, v[246:247]
    v_permlane16_swap_b32 v176, v178
    v_permlane16_swap_b32 v177, v179
    v_pk_fma_f32 v[246:247], v[28:29], 0, v[246:247]
    v_pk_fma_f32 v[246:247], v[30:31], 0, v[246:247]
    ds_write_b128 v210, v[176:179] offset:0
    v_pk_mul_f32 v[32:33], v[32:33], v[248:249]
    v_pk_mul_f32 v[34:35], v[34:35], v[248:249]
    v_pk_mul_f32 v[36:37], v[36:37], v[248:249]
    v_pk_mul_f32 v[38:39], v[38:39], v[248:249]
    v_cvt_pk_bf16_f32 v180, v32, v33
    v_cvt_pk_bf16_f32 v181, v34, v35
    v_cvt_pk_bf16_f32 v182, v36, v37
    v_cvt_pk_bf16_f32 v183, v38, v39
    v_pk_fma_f32 v[246:247], v[32:33], 0, v[246:247]
    v_pk_fma_f32 v[246:247], v[34:35], 0, v[246:247]
    v_permlane16_swap_b32 v180, v182
    v_permlane16_swap_b32 v181, v183
    v_pk_fma_f32 v[246:247], v[36:37], 0, v[246:247]
    v_pk_fma_f32 v[246:247], v[38:39], 0, v[246:247]
    ds_write_b128 v211, v[180:183] offset:0
    s_waitcnt lgkmcnt(0)
    ds_read_b128 v[8:11], v216 offset:0
    ds_read_b128 v[12:15], v216 offset:1024
    ds_read_b128 v[16:19], v216 offset:2048
    ds_read_b128 v[20:23], v216 offset:3072
    v_cmp_nle_f32 vcc, v251, s40
    v_rcp_f32 v248, v251
    s_or_b64 s[42:43], s[42:43], vcc
    v_mov_b32 v249, v248
    v_pk_mul_f32 v[40:41], v[40:41], v[248:249]
    v_pk_mul_f32 v[42:43], v[42:43], v[248:249]
    v_pk_mul_f32 v[44:45], v[44:45], v[248:249]
    v_pk_mul_f32 v[46:47], v[46:47], v[248:249]
    v_cvt_pk_bf16_f32 v168, v40, v41
    v_cvt_pk_bf16_f32 v169, v42, v43
    v_cvt_pk_bf16_f32 v170, v44, v45
    v_cvt_pk_bf16_f32 v171, v46, v47
    v_pk_fma_f32 v[246:247], v[40:41], 0, v[246:247]
    v_pk_fma_f32 v[246:247], v[42:43], 0, v[246:247]
    v_permlane16_swap_b32 v168, v170
    v_permlane16_swap_b32 v169, v171
    v_pk_fma_f32 v[246:247], v[44:45], 0, v[246:247]
    v_pk_fma_f32 v[246:247], v[46:47], 0, v[246:247]
    ds_write_b128 v208, v[168:171] offset:4096
    v_pk_mul_f32 v[48:49], v[48:49], v[248:249]
    v_pk_mul_f32 v[50:51], v[50:51], v[248:249]
    v_pk_mul_f32 v[52:53], v[52:53], v[248:249]
    v_pk_mul_f32 v[54:55], v[54:55], v[248:249]
    v_cvt_pk_bf16_f32 v172, v48, v49
    v_cvt_pk_bf16_f32 v173, v50, v51
    v_cvt_pk_bf16_f32 v174, v52, v53
    v_cvt_pk_bf16_f32 v175, v54, v55
    v_pk_fma_f32 v[246:247], v[48:49], 0, v[246:247]
    v_pk_fma_f32 v[246:247], v[50:51], 0, v[246:247]
    v_permlane16_swap_b32 v172, v174
    v_permlane16_swap_b32 v173, v175
    v_pk_fma_f32 v[246:247], v[52:53], 0, v[246:247]
    v_pk_fma_f32 v[246:247], v[54:55], 0, v[246:247]
    ds_write_b128 v209, v[172:175] offset:4096
    v_pk_mul_f32 v[56:57], v[56:57], v[248:249]
    v_pk_mul_f32 v[58:59], v[58:59], v[248:249]
    v_pk_mul_f32 v[60:61], v[60:61], v[248:249]
    v_pk_mul_f32 v[62:63], v[62:63], v[248:249]
    v_cvt_pk_bf16_f32 v176, v56, v57
    v_cvt_pk_bf16_f32 v177, v58, v59
    v_cvt_pk_bf16_f32 v178, v60, v61
    v_cvt_pk_bf16_f32 v179, v62, v63
    v_pk_fma_f32 v[246:247], v[56:57], 0, v[246:247]
    v_pk_fma_f32 v[246:247], v[58:59], 0, v[246:247]
    v_permlane16_swap_b32 v176, v178
    v_permlane16_swap_b32 v177, v179
    v_pk_fma_f32 v[246:247], v[60:61], 0, v[246:247]
    v_pk_fma_f32 v[246:247], v[62:63], 0, v[246:247]
    ds_write_b128 v210, v[176:179] offset:4096
    v_pk_mul_f32 v[64:65], v[64:65], v[248:249]
    v_pk_mul_f32 v[66:67], v[66:67], v[248:249]
    v_pk_mul_f32 v[68:69], v[68:69], v[248:249]
    v_pk_mul_f32 v[70:71], v[70:71], v[248:249]
    v_cvt_pk_bf16_f32 v180, v64, v65
    v_cvt_pk_bf16_f32 v181, v66, v67
    v_cvt_pk_bf16_f32 v182, v68, v69
    v_cvt_pk_bf16_f32 v183, v70, v71
    v_pk_fma_f32 v[246:247], v[64:65], 0, v[246:247]
    v_pk_fma_f32 v[246:247], v[66:67], 0, v[246:247]
    v_permlane16_swap_b32 v180, v182
    v_permlane16_swap_b32 v181, v183
    v_pk_fma_f32 v[246:247], v[68:69], 0, v[246:247]
    v_pk_fma_f32 v[246:247], v[70:71], 0, v[246:247]
    ds_write_b128 v211, v[180:183] offset:4096
    s_waitcnt lgkmcnt(4)
    buffer_store_dwordx4 v[8:11], v212, s[24:27], 0 offen sc1 nt
    buffer_store_dwordx4 v[12:15], v213, s[24:27], 0 offen sc1 nt
    buffer_store_dwordx4 v[16:19], v214, s[24:27], 0 offen sc1 nt
    buffer_store_dwordx4 v[20:23], v215, s[24:27], 0 offen sc1 nt
    v_accvgpr_read_b32 v244, a164
    ds_write_b128 v217, v[152:155] offset:0
    ds_write_b128 v217, v[156:159] offset:1024
    ds_write_b128 v217, v[160:163] offset:2048
    ds_write_b128 v217, v[164:167] offset:3072
    s_branch L_epi
L_ver1:
    v_exp_f32 v200, v200
    s_nop 0
    v_exp_f32 v201, v201
    s_nop 0
    v_cvt_pk_bf16_f32 v200, v200, v201
    v_exp_f32 v202, v202
    s_nop 0
    v_exp_f32 v203, v203
    s_nop 0
    v_cvt_pk_bf16_f32 v201, v202, v203
    v_exp_f32 v184, v184
    s_nop 0
    v_exp_f32 v185, v185
    s_nop 0
    v_cvt_pk_bf16_f32 v184, v184, v185
    v_exp_f32 v186, v186
    s_nop 0
    v_exp_f32 v187, v187
    s_nop 0
    v_cvt_pk_bf16_f32 v185, v186, v187
    v_exp_f32 v188, v188
    s_nop 0
    v_exp_f32 v189, v189
    s_nop 0
    v_cvt_pk_bf16_f32 v186, v188, v189
    v_exp_f32 v190, v190
    s_nop 0
    v_exp_f32 v191, v191
    s_nop 0
    v_cvt_pk_bf16_f32 v187, v190, v191
    v_exp_f32 v204, v204
    s_nop 0
    v_exp_f32 v205, v205
    s_nop 0
    v_cvt_pk_bf16_f32 v202, v204, v205
    v_exp_f32 v206, v206
    s_nop 0
    s_waitcnt vmcnt(12)
    s_barrier
    v_mfma_f32_16x16x32_bf16 v[168:171], a[80:83], a[0:3], v[208:211]
    s_branch L_in1_0
.p2align 6
L_loop1:
    s_waitcnt lgkmcnt(0)
    v_mfma_f32_16x16x32_bf16 v[168:171], a[80:83], a[0:3], v[208:211]
    s_waitcnt vmcnt(8)
    s_barrier
L_in1_0:
    v_mfma_f32_16x16x32_bf16 v[168:171], a[84:87], a[4:7], v[168:171]
    v_exp_f32 v207, v207
    v_mfma_f32_16x16x32_bf16 v[168:171], a[88:91], a[8:11], v[168:171]
    v_cvt_pk_bf16_f32 v203, v206, v207
    s_add_u32 m0, s30, 98304
    v_mfma_f32_16x16x32_bf16 v[168:171], a[92:95], a[12:15], v[168:171]
    v_exp_f32 v192, v192
    v_mfma_f32_16x16x32_bf16 v[172:175], a[96:99], a[0:3], v[208:211]
    buffer_load_dwordx4 v242, s[16:19], s31 offen nt lds
    v_mfma_f32_16x16x32_bf16 v[172:175], a[100:103], a[4:7], v[172:175]
    v_exp_f32 v193, v193
    v_mfma_f32_16x16x32_bf16 v[172:175], a[104:107], a[8:11], v[172:175]
    buffer_load_dwordx4 v243, s[16:19], s31 offen offset:1024 nt lds
    v_cvt_pk_bf16_f32 v192, v192, v193
    v_mfma_f32_16x16x32_bf16 v[172:175], a[108:111], a[12:15], v[172:175]
    v_exp_f32 v194, v194
    v_mfma_f32_16x16x32_bf16 v[176:179], a[80:83], a[16:19], v[212:215]
    s_add_u32 s31, s31, 16384
    v_mfma_f32_16x16x32_bf16 v[176:179], a[84:87], a[20:23], v[176:179]
    v_exp_f32 v195, v195
    v_mfma_f32_16x16x32_bf16 v[176:179], a[88:91], a[24:27], v[176:179]
    v_cvt_pk_bf16_f32 v193, v194, v195
    v_mfma_f32_16x16x32_bf16 v[176:179], a[92:95], a[28:31], v[176:179]
    v_exp_f32 v196, v196
    v_mfma_f32_16x16x32_bf16 v[180:183], a[96:99], a[16:19], v[212:215]
    s_cmp_lt_u32 s49, 90112
    s_cbranch_scc1 L_pf1_0_0
L_pf1_0_0r:
    v_mfma_f32_16x16x32_bf16 v[180:183], a[100:103], a[20:23], v[180:183]
    v_exp_f32 v197, v197
    v_mfma_f32_16x16x32_bf16 v[180:183], a[104:107], a[24:27], v[180:183]
    v_cvt_pk_bf16_f32 v194, v196, v197
    v_mfma_f32_16x16x32_bf16 v[180:183], a[108:111], a[28:31], v[180:183]
    v_exp_f32 v198, v198
    v_mfma_f32_16x16x32_bf16 v[136:139], a[112:115], v[200:203], v[136:139]
    v_mfma_f32_16x16x32_bf16 v[140:143], a[116:119], v[200:203], v[140:143]
    v_exp_f32 v199, v199
    v_mfma_f32_16x16x32_bf16 v[144:147], a[120:123], v[200:203], v[144:147]
    v_cvt_pk_bf16_f32 v195, v198, v199
    v_mfma_f32_16x16x32_bf16 v[148:151], a[124:127], v[200:203], v[148:151]
    v_mfma_f32_16x16x32_bf16 v[152:155], a[128:131], v[200:203], v[152:155]
    v_exp_f32 v168, v168
    v_mfma_f32_16x16x32_bf16 v[156:159], a[132:135], v[200:203], v[156:159]
    v_mfma_f32_16x16x32_bf16 v[160:163], a[136:139], v[200:203], v[160:163]
    v_exp_f32 v169, v169
    v_mfma_f32_16x16x32_bf16 v[164:167], a[140:143], v[200:203], v[164:167]
    v_cvt_pk_bf16_f32 v168, v168, v169
    v_mfma_f32_16x16x32_bf16 a[164:167], a[144:147], v[200:203], a[164:167]
    v_exp_f32 v170, v170
    v_mfma_f32_16x16x32_bf16 v[72:75], a[112:115], v[184:187], v[72:75]
    v_mfma_f32_16x16x32_bf16 v[104:107], a[112:115], v[192:195], v[104:107]
    v_exp_f32 v171, v171
    v_mfma_f32_16x16x32_bf16 v[76:79], a[116:119], v[184:187], v[76:79]
    ds_read_b64_tr_b16 a[112:113], v232 offset:0
    v_cvt_pk_bf16_f32 v169, v170, v171
    v_mfma_f32_16x16x32_bf16 v[108:111], a[116:119], v[192:195], v[108:111]
    v_exp_f32 v172, v172
    v_mfma_f32_16x16x32_bf16 v[80:83], a[120:123], v[184:187], v[80:83]
    ds_read_b64_tr_b16 a[114:115], v232 offset:4096
    v_mfma_f32_16x16x32_bf16 v[112:115], a[120:123], v[192:195], v[112:115]
    v_exp_f32 v173, v173
    v_mfma_f32_16x16x32_bf16 v[84:87], a[124:127], v[184:187], v[84:87]
    ds_read_b64_tr_b16 a[116:117], v233 offset:0
    v_cvt_pk_bf16_f32 v170, v172, v173
    v_mfma_f32_16x16x32_bf16 v[116:119], a[124:127], v[192:195], v[116:119]
    v_exp_f32 v174, v174
    v_mfma_f32_16x16x32_bf16 v[88:91], a[128:131], v[184:187], v[88:91]
    ds_read_b64_tr_b16 a[118:119], v233 offset:4096
    ds_read_b64_tr_b16 a[120:121], v234 offset:0
    v_mfma_f32_16x16x32_bf16 v[120:123], a[128:131], v[192:195], v[120:123]
    v_exp_f32 v175, v175
    v_mfma_f32_16x16x32_bf16 v[92:95], a[132:135], v[184:187], v[92:95]
    ds_read_b64_tr_b16 a[122:123], v234 offset:4096
    v_cvt_pk_bf16_f32 v171, v174, v175
    v_mfma_f32_16x16x32_bf16 v[124:127], a[132:135], v[192:195], v[124:127]
    ds_read_b64_tr_b16 a[124:125], v235 offset:0
    ds_read_b64_tr_b16 a[126:127], v235 offset:4096
    v_mfma_f32_16x16x32_bf16 v[96:99], a[136:139], v[184:187], v[96:99]
    v_exp_f32 v176, v176
    v_mfma_f32_16x16x32_bf16 v[128:131], a[136:139], v[192:195], v[128:131]
    ds_read_b64_tr_b16 a[128:129], v236 offset:0
    ds_read_b64_tr_b16 a[130:131], v236 offset:4096
    v_mfma_f32_16x16x32_bf16 v[100:103], a[140:143], v[184:187], v[100:103]
    v_exp_f32 v177, v177
    v_mfma_f32_16x16x32_bf16 v[132:135], a[140:143], v[192:195], v[132:135]
    ds_read_b64_tr_b16 a[132:133], v237 offset:0
    v_cvt_pk_bf16_f32 v176, v176, v177
    v_mfma_f32_16x16x32_bf16 a[156:159], a[144:147], v[184:187], a[156:159]
    v_exp_f32 v178, v178
    v_mfma_f32_16x16x32_bf16 a[160:163], a[144:147], v[192:195], a[160:163]
    ds_read_b64_tr_b16 a[134:135], v237 offset:4096
    s_add_u32 m0, s30, 40960
    v_mfma_f32_16x16x32_bf16 v[184:187], a[80:83], a[32:35], v[216:219]
    v_exp_f32 v179, v179
    v_mfma_f32_16x16x32_bf16 v[184:187], a[84:87], a[36:39], v[184:187]
    buffer_load_dwordx4 v240, s[12:15], s32 offen nt lds
    v_cvt_pk_bf16_f32 v177, v178, v179
    v_mfma_f32_16x16x32_bf16 v[184:187], a[88:91], a[40:43], v[184:187]
    v_exp_f32 v180, v180
    v_mfma_f32_16x16x32_bf16 v[184:187], a[92:95], a[44:47], v[184:187]
    buffer_load_dwordx4 v241, s[12:15], s32 offen offset:1024 nt lds
    ds_read_b64_tr_b16 a[136:137], v238 offset:0
    v_mfma_f32_16x16x32_bf16 v[188:191], a[96:99], a[32:35], v[216:219]
    v_exp_f32 v181, v181
    v_mfma_f32_16x16x32_bf16 v[188:191], a[100:103], a[36:39], v[188:191]
    ds_read_b64_tr_b16 a[138:139], v238 offset:4096
    v_cvt_pk_bf16_f32 v178, v180, v181
    v_mfma_f32_16x16x32_bf16 v[188:191], a[104:107], a[40:43], v[188:191]
    v_exp_f32 v182, v182
    v_mfma_f32_16x16x32_bf16 v[188:191], a[108:111], a[44:47], v[188:191]
    ds_read_b64_tr_b16 a[140:141], v239 offset:0
    ds_read_b64_tr_b16 a[142:143], v239 offset:4096
    v_mfma_f32_16x16x32_bf16 v[192:195], a[80:83], a[48:51], v[220:223]
    v_exp_f32 v183, v183
    v_mfma_f32_16x16x32_bf16 v[192:195], a[84:87], a[52:55], v[192:195]
    v_cvt_pk_bf16_f32 v179, v182, v183
    v_mfma_f32_16x16x32_bf16 v[192:195], a[88:91], a[56:59], v[192:195]
    ds_read_b128 a[80:83], v228 offset:8192
    v_mfma_f32_16x16x32_bf16 v[192:195], a[92:95], a[60:63], v[192:195]
    v_exp_f32 v184, v184
    v_mfma_f32_16x16x32_bf16 v[196:199], a[96:99], a[48:51], v[220:223]
    ds_read_b128 a[84:87], v229 offset:8192
    v_mfma_f32_16x16x32_bf16 v[196:199], a[100:103], a[52:55], v[196:199]
    v_exp_f32 v185, v185
    v_mfma_f32_16x16x32_bf16 v[196:199], a[104:107], a[56:59], v[196:199]
    v_cvt_pk_bf16_f32 v184, v184, v185
    v_mfma_f32_16x16x32_bf16 v[196:199], a[108:111], a[60:63], v[196:199]
    ds_read_b128 a[88:91], v230 offset:8192
    s_waitcnt lgkmcnt(3)
    v_mfma_f32_16x16x32_bf16 v[8:11], a[112:115], v[168:171], v[8:11]
    v_exp_f32 v186, v186
    v_mfma_f32_16x16x32_bf16 v[12:15], a[116:119], v[168:171], v[12:15]
    ds_read_b128 a[92:95], v231 offset:8192
    v_mfma_f32_16x16x32_bf16 v[16:19], a[120:123], v[168:171], v[16:19]
    v_exp_f32 v187, v187
    v_mfma_f32_16x16x32_bf16 v[20:23], a[124:127], v[168:171], v[20:23]
    ds_read_b128 a[96:99], v228 offset:12288
    v_cvt_pk_bf16_f32 v185, v186, v187
    v_mfma_f32_16x16x32_bf16 v[24:27], a[128:131], v[168:171], v[24:27]
    v_exp_f32 v188, v188
    v_mfma_f32_16x16x32_bf16 v[28:31], a[132:135], v[168:171], v[28:31]
    ds_read_b128 a[100:103], v229 offset:12288
    v_mfma_f32_16x16x32_bf16 v[32:35], a[136:139], v[168:171], v[32:35]
    v_exp_f32 v189, v189
    v_mfma_f32_16x16x32_bf16 v[36:39], a[140:143], v[168:171], v[36:39]
    ds_read_b128 a[104:107], v230 offset:12288
    v_cvt_pk_bf16_f32 v186, v188, v189
    v_mfma_f32_16x16x32_bf16 a[148:151], a[144:147], v[168:171], a[148:151]
    v_exp_f32 v190, v190
    v_mfma_f32_16x16x32_bf16 v[40:43], a[112:115], v[176:179], v[40:43]
    ds_read_b128 a[108:111], v231 offset:12288
    v_mfma_f32_16x16x32_bf16 v[44:47], a[116:119], v[176:179], v[44:47]
    v_exp_f32 v191, v191
    v_mfma_f32_16x16x32_bf16 v[48:51], a[120:123], v[176:179], v[48:51]
    v_cvt_pk_bf16_f32 v187, v190, v191
    v_mfma_f32_16x16x32_bf16 v[52:55], a[124:127], v[176:179], v[52:55]
    v_exp_f32 v192, v192
    v_mfma_f32_16x16x32_bf16 v[56:59], a[128:131], v[176:179], v[56:59]
    s_cmp_lt_u32 s49, 90112
    s_cbranch_scc1 L_pf1_1_0
L_pf1_1_0r:
    v_mfma_f32_16x16x32_bf16 v[60:63], a[132:135], v[176:179], v[60:63]
    v_exp_f32 v193, v193
    v_mfma_f32_16x16x32_bf16 v[64:67], a[136:139], v[176:179], v[64:67]
    v_cvt_pk_bf16_f32 v192, v192, v193
    v_mfma_f32_16x16x32_bf16 v[68:71], a[140:143], v[176:179], v[68:71]
    v_exp_f32 v194, v194
    v_mfma_f32_16x16x32_bf16 a[152:155], a[144:147], v[176:179], a[152:155]
    s_waitcnt lgkmcnt(0)
    v_mfma_f32_16x16x32_bf16 v[168:171], a[80:83], a[0:3], v[208:211]
    v_exp_f32 v195, v195
    v_mfma_f32_16x16x32_bf16 v[168:171], a[84:87], a[4:7], v[168:171]
    v_cvt_pk_bf16_f32 v193, v194, v195
    v_mfma_f32_16x16x32_bf16 v[168:171], a[88:91], a[8:11], v[168:171]
    v_exp_f32 v196, v196
    v_mfma_f32_16x16x32_bf16 v[168:171], a[92:95], a[12:15], v[168:171]
    v_mfma_f32_16x16x32_bf16 v[172:175], a[96:99], a[0:3], v[208:211]
    v_exp_f32 v197, v197
    v_mfma_f32_16x16x32_bf16 v[172:175], a[100:103], a[4:7], v[172:175]
    v_cvt_pk_bf16_f32 v194, v196, v197
    s_add_u32 m0, s30, 106496
    v_mfma_f32_16x16x32_bf16 v[172:175], a[104:107], a[8:11], v[172:175]
    v_exp_f32 v198, v198
    v_mfma_f32_16x16x32_bf16 v[172:175], a[108:111], a[12:15], v[172:175]
    buffer_load_dwordx4 v242, s[16:19], s32 offen nt lds
    v_mfma_f32_16x16x32_bf16 v[176:179], a[80:83], a[16:19], v[212:215]
    v_exp_f32 v199, v199
    v_mfma_f32_16x16x32_bf16 v[176:179], a[84:87], a[20:23], v[176:179]
    buffer_load_dwordx4 v243, s[16:19], s32 offen offset:1024 nt lds
    v_cvt_pk_bf16_f32 v195, v198, v199
    v_mfma_f32_16x16x32_bf16 v[176:179], a[88:91], a[24:27], v[176:179]
    s_add_u32 s32, s32, 16384
    v_mfma_f32_16x16x32_bf16 v[176:179], a[92:95], a[28:31], v[176:179]
    v_exp_f32 v168, v168
    v_mfma_f32_16x16x32_bf16 v[180:183], a[96:99], a[16:19], v[212:215]
    v_mfma_f32_16x16x32_bf16 v[180:183], a[100:103], a[20:23], v[180:183]
    v_exp_f32 v169, v169
    v_mfma_f32_16x16x32_bf16 v[180:183], a[104:107], a[24:27], v[180:183]
    v_cvt_pk_bf16_f32 v168, v168, v169
    v_mfma_f32_16x16x32_bf16 v[180:183], a[108:111], a[28:31], v[180:183]
    v_exp_f32 v170, v170
    v_mfma_f32_16x16x32_bf16 v[72:75], a[112:115], v[184:187], v[72:75]
    v_mfma_f32_16x16x32_bf16 v[104:107], a[112:115], v[192:195], v[104:107]
    v_exp_f32 v171, v171
    v_mfma_f32_16x16x32_bf16 v[76:79], a[116:119], v[184:187], v[76:79]
    ds_read_b64_tr_b16 a[112:113], v232 offset:8192
    v_cvt_pk_bf16_f32 v169, v170, v171
    v_mfma_f32_16x16x32_bf16 v[108:111], a[116:119], v[192:195], v[108:111]
    v_exp_f32 v172, v172
    v_mfma_f32_16x16x32_bf16 v[80:83], a[120:123], v[184:187], v[80:83]
    s_cmp_lt_u32 s49, 90112
    s_cbranch_scc1 L_pf1_2_0
L_pf1_2_0r:
    v_mfma_f32_16x16x32_bf16 v[112:115], a[120:123], v[192:195], v[112:115]
    v_exp_f32 v173, v173
    v_mfma_f32_16x16x32_bf16 v[84:87], a[124:127], v[184:187], v[84:87]
    ds_read_b64_tr_b16 a[114:115], v232 offset:12288
    v_cvt_pk_bf16_f32 v170, v172, v173
    v_mfma_f32_16x16x32_bf16 v[116:119], a[124:127], v[192:195], v[116:119]
    v_exp_f32 v174, v174
    v_mfma_f32_16x16x32_bf16 v[88:91], a[128:131], v[184:187], v[88:91]
    ds_read_b64_tr_b16 a[116:117], v233 offset:8192
    ds_read_b64_tr_b16 a[118:119], v233 offset:12288
    v_mfma_f32_16x16x32_bf16 v[120:123], a[128:131], v[192:195], v[120:123]
    v_exp_f32 v175, v175
    v_mfma_f32_16x16x32_bf16 v[92:95], a[132:135], v[184:187], v[92:95]
    v_cvt_pk_bf16_f32 v171, v174, v175
    v_mfma_f32_16x16x32_bf16 v[124:127], a[132:135], v[192:195], v[124:127]
    ds_read_b64_tr_b16 a[120:121], v234 offset:8192
    v_mfma_f32_16x16x32_bf16 v[96:99], a[136:139], v[184:187], v[96:99]
    v_exp_f32 v176, v176
    v_mfma_f32_16x16x32_bf16 v[128:131], a[136:139], v[192:195], v[128:131]
    ds_read_b64_tr_b16 a[122:123], v234 offset:12288
    v_mfma_f32_16x16x32_bf16 v[100:103], a[140:143], v[184:187], v[100:103]
    v_exp_f32 v177, v177
    v_mfma_f32_16x16x32_bf16 v[132:135], a[140:143], v[192:195], v[132:135]
    ds_read_b64_tr_b16 a[124:125], v235 offset:8192
    v_cvt_pk_bf16_f32 v176, v176, v177
    v_mfma_f32_16x16x32_bf16 a[156:159], a[144:147], v[184:187], a[156:159]
    v_exp_f32 v178, v178
    v_mfma_f32_16x16x32_bf16 a[160:163], a[144:147], v[192:195], a[160:163]
    ds_read_b64_tr_b16 a[126:127], v235 offset:12288
    v_mfma_f32_16x16x32_bf16 v[200:203], a[80:83], a[64:67], v[224:227]
    v_exp_f32 v179, v179
    v_mfma_f32_16x16x32_bf16 v[200:203], a[84:87], a[68:71], v[200:203]
    ds_read_b64_tr_b16 a[128:129], v236 offset:8192
    v_cvt_pk_bf16_f32 v177, v178, v179
    v_mfma_f32_16x16x32_bf16 v[200:203], a[88:91], a[72:75], v[200:203]
    v_exp_f32 v180, v180
    v_mfma_f32_16x16x32_bf16 v[200:203], a[92:95], a[76:79], v[200:203]
    ds_read_b64_tr_b16 a[130:131], v236 offset:12288
    v_mfma_f32_16x16x32_bf16 v[204:207], a[96:99], a[64:67], v[224:227]
    v_exp_f32 v181, v181
    v_mfma_f32_16x16x32_bf16 v[204:207], a[100:103], a[68:71], v[204:207]
    ds_read_b64_tr_b16 a[132:133], v237 offset:8192
    v_cvt_pk_bf16_f32 v178, v180, v181
    v_mfma_f32_16x16x32_bf16 v[204:207], a[104:107], a[72:75], v[204:207]
    v_exp_f32 v182, v182
    v_mfma_f32_16x16x32_bf16 v[204:207], a[108:111], a[76:79], v[204:207]
    ds_read_b64_tr_b16 a[134:135], v237 offset:12288
    v_mfma_f32_16x16x32_bf16 v[184:187], a[80:83], a[32:35], v[216:219]
    v_exp_f32 v183, v183
    v_mfma_f32_16x16x32_bf16 v[184:187], a[84:87], a[36:39], v[184:187]
    v_cvt_pk_bf16_f32 v179, v182, v183
    s_add_u32 m0, s30, 49152
    v_mfma_f32_16x16x32_bf16 v[184:187], a[88:91], a[40:43], v[184:187]
    buffer_load_dwordx4 v240, s[12:15], s31 offen nt lds
    ds_read_b64_tr_b16 a[136:137], v238 offset:8192
    v_mfma_f32_16x16x32_bf16 v[184:187], a[92:95], a[44:47], v[184:187]
    v_exp_f32 v200, v200
    v_mfma_f32_16x16x32_bf16 v[188:191], a[96:99], a[32:35], v[216:219]
    buffer_load_dwordx4 v241, s[12:15], s31 offen offset:1024 nt lds
    ds_read_b64_tr_b16 a[138:139], v238 offset:12288
    v_mfma_f32_16x16x32_bf16 v[188:191], a[100:103], a[36:39], v[188:191]
    v_exp_f32 v201, v201
    v_mfma_f32_16x16x32_bf16 v[188:191], a[104:107], a[40:43], v[188:191]
    ds_read_b64_tr_b16 a[140:141], v239 offset:8192
    v_cvt_pk_bf16_f32 v200, v200, v201
    v_mfma_f32_16x16x32_bf16 v[188:191], a[108:111], a[44:47], v[188:191]
    v_exp_f32 v202, v202
    v_mfma_f32_16x16x32_bf16 v[192:195], a[80:83], a[48:51], v[220:223]
    ds_read_b64_tr_b16 a[142:143], v239 offset:12288
    v_mfma_f32_16x16x32_bf16 v[192:195], a[84:87], a[52:55], v[192:195]
    v_exp_f32 v203, v203
    v_mfma_f32_16x16x32_bf16 v[192:195], a[88:91], a[56:59], v[192:195]
    ds_read_b128 a[80:83], v228 offset:16384
    v_cvt_pk_bf16_f32 v201, v202, v203
    v_mfma_f32_16x16x32_bf16 v[192:195], a[92:95], a[60:63], v[192:195]
    v_exp_f32 v184, v184
    v_mfma_f32_16x16x32_bf16 v[196:199], a[96:99], a[48:51], v[220:223]
    ds_read_b128 a[84:87], v229 offset:16384
    v_mfma_f32_16x16x32_bf16 v[196:199], a[100:103], a[52:55], v[196:199]
    v_exp_f32 v185, v185
    v_mfma_f32_16x16x32_bf16 v[196:199], a[104:107], a[56:59], v[196:199]
    v_cvt_pk_bf16_f32 v184, v184, v185
    v_mfma_f32_16x16x32_bf16 v[196:199], a[108:111], a[60:63], v[196:199]
    ds_read_b128 a[88:91], v230 offset:16384
    s_waitcnt lgkmcnt(3)
    v_mfma_f32_16x16x32_bf16 v[8:11], a[112:115], v[168:171], v[8:11]
    v_exp_f32 v186, v186
    v_mfma_f32_16x16x32_bf16 v[12:15], a[116:119], v[168:171], v[12:15]
    ds_read_b128 a[92:95], v231 offset:16384
    v_mfma_f32_16x16x32_bf16 v[16:19], a[120:123], v[168:171], v[16:19]
    v_exp_f32 v187, v187
    v_mfma_f32_16x16x32_bf16 v[20:23], a[124:127], v[168:171], v[20:23]
    ds_read_b128 a[96:99], v228 offset:20480
    v_cvt_pk_bf16_f32 v185, v186, v187
    v_mfma_f32_16x16x32_bf16 v[24:27], a[128:131], v[168:171], v[24:27]
    v_exp_f32 v188, v188
    v_mfma_f32_16x16x32_bf16 v[28:31], a[132:135], v[168:171], v[28:31]
    ds_read_b128 a[100:103], v229 offset:20480
    v_mfma_f32_16x16x32_bf16 v[32:35], a[136:139], v[168:171], v[32:35]
    v_exp_f32 v189, v189
    v_mfma_f32_16x16x32_bf16 v[36:39], a[140:143], v[168:171], v[36:39]
    ds_read_b128 a[104:107], v230 offset:20480
    v_cvt_pk_bf16_f32 v186, v188, v189
    v_mfma_f32_16x16x32_bf16 a[148:151], a[144:147], v[168:171], a[148:151]
    v_exp_f32 v190, v190
    v_mfma_f32_16x16x32_bf16 v[40:43], a[112:115], v[176:179], v[40:43]
    ds_read_b128 a[108:111], v231 offset:20480
    v_mfma_f32_16x16x32_bf16 v[44:47], a[116:119], v[176:179], v[44:47]
    v_exp_f32 v191, v191
    v_mfma_f32_16x16x32_bf16 v[48:51], a[120:123], v[176:179], v[48:51]
    v_cvt_pk_bf16_f32 v187, v190, v191
    v_mfma_f32_16x16x32_bf16 v[52:55], a[124:127], v[176:179], v[52:55]
    v_exp_f32 v204, v204
    v_mfma_f32_16x16x32_bf16 v[56:59], a[128:131], v[176:179], v[56:59]
    v_mfma_f32_16x16x32_bf16 v[60:63], a[132:135], v[176:179], v[60:63]
    v_exp_f32 v205, v205
    v_mfma_f32_16x16x32_bf16 v[64:67], a[136:139], v[176:179], v[64:67]
    v_cvt_pk_bf16_f32 v202, v204, v205
    v_mfma_f32_16x16x32_bf16 v[68:71], a[140:143], v[176:179], v[68:71]
    v_exp_f32 v206, v206
    v_mfma_f32_16x16x32_bf16 a[152:155], a[144:147], v[176:179], a[152:155]
    s_waitcnt lgkmcnt(0)
    v_mfma_f32_16x16x32_bf16 v[168:171], a[80:83], a[0:3], v[208:211]
    s_waitcnt vmcnt(8)
    s_barrier
L_in1_1:
    v_mfma_f32_16x16x32_bf16 v[168:171], a[84:87], a[4:7], v[168:171]
    v_exp_f32 v207, v207
    v_mfma_f32_16x16x32_bf16 v[168:171], a[88:91], a[8:11], v[168:171]
    v_cvt_pk_bf16_f32 v203, v206, v207
    s_add_u32 m0, s30, 114688
    v_mfma_f32_16x16x32_bf16 v[168:171], a[92:95], a[12:15], v[168:171]
    v_exp_f32 v192, v192
    v_mfma_f32_16x16x32_bf16 v[172:175], a[96:99], a[0:3], v[208:211]
    buffer_load_dwordx4 v242, s[16:19], s31 offen nt lds
    v_mfma_f32_16x16x32_bf16 v[172:175], a[100:103], a[4:7], v[172:175]
    v_exp_f32 v193, v193
    v_mfma_f32_16x16x32_bf16 v[172:175], a[104:107], a[8:11], v[172:175]
    buffer_load_dwordx4 v243, s[16:19], s31 offen offset:1024 nt lds
    v_cvt_pk_bf16_f32 v192, v192, v193
    v_mfma_f32_16x16x32_bf16 v[172:175], a[108:111], a[12:15], v[172:175]
    v_exp_f32 v194, v194
    v_mfma_f32_16x16x32_bf16 v[176:179], a[80:83], a[16:19], v[212:215]
    s_add_u32 s31, s31, 16384
    v_mfma_f32_16x16x32_bf16 v[176:179], a[84:87], a[20:23], v[176:179]
    v_exp_f32 v195, v195
    v_mfma_f32_16x16x32_bf16 v[176:179], a[88:91], a[24:27], v[176:179]
    v_cvt_pk_bf16_f32 v193, v194, v195
    v_mfma_f32_16x16x32_bf16 v[176:179], a[92:95], a[28:31], v[176:179]
    v_exp_f32 v196, v196
    v_mfma_f32_16x16x32_bf16 v[180:183], a[96:99], a[16:19], v[212:215]
    s_cmp_lt_u32 s49, 90112
    s_cbranch_scc1 L_pf1_0_1
L_pf1_0_1r:
    v_mfma_f32_16x16x32_bf16 v[180:183], a[100:103], a[20:23], v[180:183]
    v_exp_f32 v197, v197
    v_mfma_f32_16x16x32_bf16 v[180:183], a[104:107], a[24:27], v[180:183]
    v_cvt_pk_bf16_f32 v194, v196, v197
    v_mfma_f32_16x16x32_bf16 v[180:183], a[108:111], a[28:31], v[180:183]
    v_exp_f32 v198, v198
    v_mfma_f32_16x16x32_bf16 v[136:139], a[112:115], v[200:203], v[136:139]
    v_mfma_f32_16x16x32_bf16 v[140:143], a[116:119], v[200:203], v[140:143]
    v_exp_f32 v199, v199
    v_mfma_f32_16x16x32_bf16 v[144:147], a[120:123], v[200:203], v[144:147]
    v_cvt_pk_bf16_f32 v195, v198, v199
    v_mfma_f32_16x16x32_bf16 v[148:151], a[124:127], v[200:203], v[148:151]
    v_mfma_f32_16x16x32_bf16 v[152:155], a[128:131], v[200:203], v[152:155]
    v_exp_f32 v168, v168
    v_mfma_f32_16x16x32_bf16 v[156:159], a[132:135], v[200:203], v[156:159]
    v_mfma_f32_16x16x32_bf16 v[160:163], a[136:139], v[200:203], v[160:163]
    v_exp_f32 v169, v169
    v_mfma_f32_16x16x32_bf16 v[164:167], a[140:143], v[200:203], v[164:167]
    v_cvt_pk_bf16_f32 v168, v168, v169
    v_mfma_f32_16x16x32_bf16 a[164:167], a[144:147], v[200:203], a[164:167]
    v_exp_f32 v170, v170
    v_mfma_f32_16x16x32_bf16 v[72:75], a[112:115], v[184:187], v[72:75]
    v_mfma_f32_16x16x32_bf16 v[104:107], a[112:115], v[192:195], v[104:107]
    v_exp_f32 v171, v171
    v_mfma_f32_16x16x32_bf16 v[76:79], a[116:119], v[184:187], v[76:79]
    ds_read_b64_tr_b16 a[112:113], v232 offset:16384
    v_cvt_pk_bf16_f32 v169, v170, v171
    v_mfma_f32_16x16x32_bf16 v[108:111], a[116:119], v[192:195], v[108:111]
    v_exp_f32 v172, v172
    v_mfma_f32_16x16x32_bf16 v[80:83], a[120:123], v[184:187], v[80:83]
    ds_read_b64_tr_b16 a[114:115], v232 offset:20480
    v_mfma_f32_16x16x32_bf16 v[112:115], a[120:123], v[192:195], v[112:115]
    v_exp_f32 v173, v173
    v_mfma_f32_16x16x32_bf16 v[84:87], a[124:127], v[184:187], v[84:87]
    ds_read_b64_tr_b16 a[116:117], v233 offset:16384
    v_cvt_pk_bf16_f32 v170, v172, v173
    v_mfma_f32_16x16x32_bf16 v[116:119], a[124:127], v[192:195], v[116:119]
    v_exp_f32 v174, v174
    v_mfma_f32_16x16x32_bf16 v[88:91], a[128:131], v[184:187], v[88:91]
    ds_read_b64_tr_b16 a[118:119], v233 offset:20480
    ds_read_b64_tr_b16 a[120:121], v234 offset:16384
    v_mfma_f32_16x16x32_bf16 v[120:123], a[128:131], v[192:195], v[120:123]
    v_exp_f32 v175, v175
    v_mfma_f32_16x16x32_bf16 v[92:95], a[132:135], v[184:187], v[92:95]
    ds_read_b64_tr_b16 a[122:123], v234 offset:20480
    v_cvt_pk_bf16_f32 v171, v174, v175
    v_mfma_f32_16x16x32_bf16 v[124:127], a[132:135], v[192:195], v[124:127]
    ds_read_b64_tr_b16 a[124:125], v235 offset:16384
    ds_read_b64_tr_b16 a[126:127], v235 offset:20480
    v_mfma_f32_16x16x32_bf16 v[96:99], a[136:139], v[184:187], v[96:99]
    v_exp_f32 v176, v176
    v_mfma_f32_16x16x32_bf16 v[128:131], a[136:139], v[192:195], v[128:131]
    ds_read_b64_tr_b16 a[128:129], v236 offset:16384
    ds_read_b64_tr_b16 a[130:131], v236 offset:20480
    v_mfma_f32_16x16x32_bf16 v[100:103], a[140:143], v[184:187], v[100:103]
    v_exp_f32 v177, v177
    v_mfma_f32_16x16x32_bf16 v[132:135], a[140:143], v[192:195], v[132:135]
    ds_read_b64_tr_b16 a[132:133], v237 offset:16384
    v_cvt_pk_bf16_f32 v176, v176, v177
    v_mfma_f32_16x16x32_bf16 a[156:159], a[144:147], v[184:187], a[156:159]
    v_exp_f32 v178, v178
    v_mfma_f32_16x16x32_bf16 a[160:163], a[144:147], v[192:195], a[160:163]
    ds_read_b64_tr_b16 a[134:135], v237 offset:20480
    s_add_u32 m0, s30, 57344
    v_mfma_f32_16x16x32_bf16 v[184:187], a[80:83], a[32:35], v[216:219]
    v_exp_f32 v179, v179
    v_mfma_f32_16x16x32_bf16 v[184:187], a[84:87], a[36:39], v[184:187]
    buffer_load_dwordx4 v240, s[12:15], s32 offen nt lds
    v_cvt_pk_bf16_f32 v177, v178, v179
    v_mfma_f32_16x16x32_bf16 v[184:187], a[88:91], a[40:43], v[184:187]
    v_exp_f32 v180, v180
    v_mfma_f32_16x16x32_bf16 v[184:187], a[92:95], a[44:47], v[184:187]
    buffer_load_dwordx4 v241, s[12:15], s32 offen offset:1024 nt lds
    ds_read_b64_tr_b16 a[136:137], v238 offset:16384
    v_mfma_f32_16x16x32_bf16 v[188:191], a[96:99], a[32:35], v[216:219]
    v_exp_f32 v181, v181
    v_mfma_f32_16x16x32_bf16 v[188:191], a[100:103], a[36:39], v[188:191]
    ds_read_b64_tr_b16 a[138:139], v238 offset:20480
    v_cvt_pk_bf16_f32 v178, v180, v181
    v_mfma_f32_16x16x32_bf16 v[188:191], a[104:107], a[40:43], v[188:191]
    v_exp_f32 v182, v182
    v_mfma_f32_16x16x32_bf16 v[188:191], a[108:111], a[44:47], v[188:191]
    ds_read_b64_tr_b16 a[140:141], v239 offset:16384
    ds_read_b64_tr_b16 a[142:143], v239 offset:20480
    v_mfma_f32_16x16x32_bf16 v[192:195], a[80:83], a[48:51], v[220:223]
    v_exp_f32 v183, v183
    v_mfma_f32_16x16x32_bf16 v[192:195], a[84:87], a[52:55], v[192:195]
    v_cvt_pk_bf16_f32 v179, v182, v183
    v_mfma_f32_16x16x32_bf16 v[192:195], a[88:91], a[56:59], v[192:195]
    ds_read_b128 a[80:83], v228 offset:24576
    v_mfma_f32_16x16x32_bf16 v[192:195], a[92:95], a[60:63], v[192:195]
    v_exp_f32 v184, v184
    v_mfma_f32_16x16x32_bf16 v[196:199], a[96:99], a[48:51], v[220:223]
    ds_read_b128 a[84:87], v229 offset:24576
    v_mfma_f32_16x16x32_bf16 v[196:199], a[100:103], a[52:55], v[196:199]
    v_exp_f32 v185, v185
    v_mfma_f32_16x16x32_bf16 v[196:199], a[104:107], a[56:59], v[196:199]
    v_cvt_pk_bf16_f32 v184, v184, v185
    v_mfma_f32_16x16x32_bf16 v[196:199], a[108:111], a[60:63], v[196:199]
    ds_read_b128 a[88:91], v230 offset:24576
    s_waitcnt lgkmcnt(3)
    v_mfma_f32_16x16x32_bf16 v[8:11], a[112:115], v[168:171], v[8:11]
    v_exp_f32 v186, v186
    v_mfma_f32_16x16x32_bf16 v[12:15], a[116:119], v[168:171], v[12:15]
    ds_read_b128 a[92:95], v231 offset:24576
    v_mfma_f32_16x16x32_bf16 v[16:19], a[120:123], v[168:171], v[16:19]
    v_exp_f32 v187, v187
    v_mfma_f32_16x16x32_bf16 v[20:23], a[124:127], v[168:171], v[20:23]
    ds_read_b128 a[96:99], v228 offset:28672
    v_cvt_pk_bf16_f32 v185, v186, v187
    v_mfma_f32_16x16x32_bf16 v[24:27], a[128:131], v[168:171], v[24:27]
    v_exp_f32 v188, v188
    v_mfma_f32_16x16x32_bf16 v[28:31], a[132:135], v[168:171], v[28:31]
    ds_read_b128 a[100:103], v229 offset:28672
    v_mfma_f32_16x16x32_bf16 v[32:35], a[136:139], v[168:171], v[32:35]
    v_exp_f32 v189, v189
    v_mfma_f32_16x16x32_bf16 v[36:39], a[140:143], v[168:171], v[36:39]
    ds_read_b128 a[104:107], v230 offset:28672
    v_cvt_pk_bf16_f32 v186, v188, v189
    v_mfma_f32_16x16x32_bf16 a[148:151], a[144:147], v[168:171], a[148:151]
    v_exp_f32 v190, v190
    v_mfma_f32_16x16x32_bf16 v[40:43], a[112:115], v[176:179], v[40:43]
    ds_read_b128 a[108:111], v231 offset:28672
    v_mfma_f32_16x16x32_bf16 v[44:47], a[116:119], v[176:179], v[44:47]
    v_exp_f32 v191, v191
    v_mfma_f32_16x16x32_bf16 v[48:51], a[120:123], v[176:179], v[48:51]
    v_cvt_pk_bf16_f32 v187, v190, v191
    v_mfma_f32_16x16x32_bf16 v[52:55], a[124:127], v[176:179], v[52:55]
    v_exp_f32 v192, v192
    v_mfma_f32_16x16x32_bf16 v[56:59], a[128:131], v[176:179], v[56:59]
    s_cmp_lt_u32 s49, 90112
    s_cbranch_scc1 L_pf1_1_1
L_pf1_1_1r:
    v_mfma_f32_16x16x32_bf16 v[60:63], a[132:135], v[176:179], v[60:63]
    v_exp_f32 v193, v193
    v_mfma_f32_16x16x32_bf16 v[64:67], a[136:139], v[176:179], v[64:67]
    v_cvt_pk_bf16_f32 v192, v192, v193
    v_mfma_f32_16x16x32_bf16 v[68:71], a[140:143], v[176:179], v[68:71]
    v_exp_f32 v194, v194
    v_mfma_f32_16x16x32_bf16 a[152:155], a[144:147], v[176:179], a[152:155]
    s_waitcnt lgkmcnt(0)
    v_mfma_f32_16x16x32_bf16 v[168:171], a[80:83], a[0:3], v[208:211]
    v_exp_f32 v195, v195
    v_mfma_f32_16x16x32_bf16 v[168:171], a[84:87], a[4:7], v[168:171]
    v_cvt_pk_bf16_f32 v193, v194, v195
    v_mfma_f32_16x16x32_bf16 v[168:171], a[88:91], a[8:11], v[168:171]
    v_exp_f32 v196, v196
    v_mfma_f32_16x16x32_bf16 v[168:171], a[92:95], a[12:15], v[168:171]
    v_mfma_f32_16x16x32_bf16 v[172:175], a[96:99], a[0:3], v[208:211]
    v_exp_f32 v197, v197
    v_mfma_f32_16x16x32_bf16 v[172:175], a[100:103], a[4:7], v[172:175]
    v_cvt_pk_bf16_f32 v194, v196, v197
    s_add_u32 m0, s30, 122880
    v_mfma_f32_16x16x32_bf16 v[172:175], a[104:107], a[8:11], v[172:175]
    v_exp_f32 v198, v198
    v_mfma_f32_16x16x32_bf16 v[172:175], a[108:111], a[12:15], v[172:175]
    buffer_load_dwordx4 v242, s[16:19], s32 offen nt lds
    v_mfma_f32_16x16x32_bf16 v[176:179], a[80:83], a[16:19], v[212:215]
    v_exp_f32 v199, v199
    v_mfma_f32_16x16x32_bf16 v[176:179], a[84:87], a[20:23], v[176:179]
    buffer_load_dwordx4 v243, s[16:19], s32 offen offset:1024 nt lds
    v_cvt_pk_bf16_f32 v195, v198, v199
    v_mfma_f32_16x16x32_bf16 v[176:179], a[88:91], a[24:27], v[176:179]
    s_add_u32 s32, s32, 16384
    v_mfma_f32_16x16x32_bf16 v[176:179], a[92:95], a[28:31], v[176:179]
    v_exp_f32 v168, v168
    v_mfma_f32_16x16x32_bf16 v[180:183], a[96:99], a[16:19], v[212:215]
    v_mfma_f32_16x16x32_bf16 v[180:183], a[100:103], a[20:23], v[180:183]
    v_exp_f32 v169, v169
    v_mfma_f32_16x16x32_bf16 v[180:183], a[104:107], a[24:27], v[180:183]
    v_cvt_pk_bf16_f32 v168, v168, v169
    v_mfma_f32_16x16x32_bf16 v[180:183], a[108:111], a[28:31], v[180:183]
    v_exp_f32 v170, v170
    v_mfma_f32_16x16x32_bf16 v[72:75], a[112:115], v[184:187], v[72:75]
    v_mfma_f32_16x16x32_bf16 v[104:107], a[112:115], v[192:195], v[104:107]
    v_exp_f32 v171, v171
    v_mfma_f32_16x16x32_bf16 v[76:79], a[116:119], v[184:187], v[76:79]
    ds_read_b64_tr_b16 a[112:113], v232 offset:24576
    v_cvt_pk_bf16_f32 v169, v170, v171
    v_mfma_f32_16x16x32_bf16 v[108:111], a[116:119], v[192:195], v[108:111]
    v_exp_f32 v172, v172
    v_mfma_f32_16x16x32_bf16 v[80:83], a[120:123], v[184:187], v[80:83]
    s_cmp_lt_u32 s49, 90112
    s_cbranch_scc1 L_pf1_2_1
L_pf1_2_1r:
    v_mfma_f32_16x16x32_bf16 v[112:115], a[120:123], v[192:195], v[112:115]
    v_exp_f32 v173, v173
    v_mfma_f32_16x16x32_bf16 v[84:87], a[124:127], v[184:187], v[84:87]
    ds_read_b64_tr_b16 a[114:115], v232 offset:28672
    v_cvt_pk_bf16_f32 v170, v172, v173
    v_mfma_f32_16x16x32_bf16 v[116:119], a[124:127], v[192:195], v[116:119]
    v_exp_f32 v174, v174
    v_mfma_f32_16x16x32_bf16 v[88:91], a[128:131], v[184:187], v[88:91]
    ds_read_b64_tr_b16 a[116:117], v233 offset:24576
    ds_read_b64_tr_b16 a[118:119], v233 offset:28672
    v_mfma_f32_16x16x32_bf16 v[120:123], a[128:131], v[192:195], v[120:123]
    v_exp_f32 v175, v175
    v_mfma_f32_16x16x32_bf16 v[92:95], a[132:135], v[184:187], v[92:95]
    v_cvt_pk_bf16_f32 v171, v174, v175
    v_mfma_f32_16x16x32_bf16 v[124:127], a[132:135], v[192:195], v[124:127]
    ds_read_b64_tr_b16 a[120:121], v234 offset:24576
    v_mfma_f32_16x16x32_bf16 v[96:99], a[136:139], v[184:187], v[96:99]
    v_exp_f32 v176, v176
    v_mfma_f32_16x16x32_bf16 v[128:131], a[136:139], v[192:195], v[128:131]
    ds_read_b64_tr_b16 a[122:123], v234 offset:28672
    v_mfma_f32_16x16x32_bf16 v[100:103], a[140:143], v[184:187], v[100:103]
    v_exp_f32 v177, v177
    v_mfma_f32_16x16x32_bf16 v[132:135], a[140:143], v[192:195], v[132:135]
    ds_read_b64_tr_b16 a[124:125], v235 offset:24576
    v_cvt_pk_bf16_f32 v176, v176, v177
    v_mfma_f32_16x16x32_bf16 a[156:159], a[144:147], v[184:187], a[156:159]
    v_exp_f32 v178, v178
    v_mfma_f32_16x16x32_bf16 a[160:163], a[144:147], v[192:195], a[160:163]
    ds_read_b64_tr_b16 a[126:127], v235 offset:28672
    v_mfma_f32_16x16x32_bf16 v[200:203], a[80:83], a[64:67], v[224:227]
    v_exp_f32 v179, v179
    v_mfma_f32_16x16x32_bf16 v[200:203], a[84:87], a[68:71], v[200:203]
    ds_read_b64_tr_b16 a[128:129], v236 offset:24576
    v_cvt_pk_bf16_f32 v177, v178, v179
    v_mfma_f32_16x16x32_bf16 v[200:203], a[88:91], a[72:75], v[200:203]
    v_exp_f32 v180, v180
    v_mfma_f32_16x16x32_bf16 v[200:203], a[92:95], a[76:79], v[200:203]
    ds_read_b64_tr_b16 a[130:131], v236 offset:28672
    v_mfma_f32_16x16x32_bf16 v[204:207], a[96:99], a[64:67], v[224:227]
    v_exp_f32 v181, v181
    v_mfma_f32_16x16x32_bf16 v[204:207], a[100:103], a[68:71], v[204:207]
    ds_read_b64_tr_b16 a[132:133], v237 offset:24576
    v_cvt_pk_bf16_f32 v178, v180, v181
    v_mfma_f32_16x16x32_bf16 v[204:207], a[104:107], a[72:75], v[204:207]
    v_exp_f32 v182, v182
    v_mfma_f32_16x16x32_bf16 v[204:207], a[108:111], a[76:79], v[204:207]
    ds_read_b64_tr_b16 a[134:135], v237 offset:28672
    v_mfma_f32_16x16x32_bf16 v[184:187], a[80:83], a[32:35], v[216:219]
    v_exp_f32 v183, v183
    v_mfma_f32_16x16x32_bf16 v[184:187], a[84:87], a[36:39], v[184:187]
    v_cvt_pk_bf16_f32 v179, v182, v183
    s_add_u32 m0, s30, 0
    v_mfma_f32_16x16x32_bf16 v[184:187], a[88:91], a[40:43], v[184:187]
    buffer_load_dwordx4 v240, s[12:15], s31 offen nt lds
    ds_read_b64_tr_b16 a[136:137], v238 offset:24576
    v_mfma_f32_16x16x32_bf16 v[184:187], a[92:95], a[44:47], v[184:187]
    v_exp_f32 v200, v200
    v_mfma_f32_16x16x32_bf16 v[188:191], a[96:99], a[32:35], v[216:219]
    buffer_load_dwordx4 v241, s[12:15], s31 offen offset:1024 nt lds
    ds_read_b64_tr_b16 a[138:139], v238 offset:28672
    v_mfma_f32_16x16x32_bf16 v[188:191], a[100:103], a[36:39], v[188:191]
    v_exp_f32 v201, v201
    v_mfma_f32_16x16x32_bf16 v[188:191], a[104:107], a[40:43], v[188:191]
    ds_read_b64_tr_b16 a[140:141], v239 offset:24576
    v_cvt_pk_bf16_f32 v200, v200, v201
    v_mfma_f32_16x16x32_bf16 v[188:191], a[108:111], a[44:47], v[188:191]
    v_exp_f32 v202, v202
    v_mfma_f32_16x16x32_bf16 v[192:195], a[80:83], a[48:51], v[220:223]
    ds_read_b64_tr_b16 a[142:143], v239 offset:28672
    v_mfma_f32_16x16x32_bf16 v[192:195], a[84:87], a[52:55], v[192:195]
    v_exp_f32 v203, v203
    v_mfma_f32_16x16x32_bf16 v[192:195], a[88:91], a[56:59], v[192:195]
    ds_read_b128 a[80:83], v228 offset:32768
    v_cvt_pk_bf16_f32 v201, v202, v203
    v_mfma_f32_16x16x32_bf16 v[192:195], a[92:95], a[60:63], v[192:195]
    v_exp_f32 v184, v184
    v_mfma_f32_16x16x32_bf16 v[196:199], a[96:99], a[48:51], v[220:223]
    ds_read_b128 a[84:87], v229 offset:32768
    v_mfma_f32_16x16x32_bf16 v[196:199], a[100:103], a[52:55], v[196:199]
    v_exp_f32 v185, v185
    v_mfma_f32_16x16x32_bf16 v[196:199], a[104:107], a[56:59], v[196:199]
    v_cvt_pk_bf16_f32 v184, v184, v185
    v_mfma_f32_16x16x32_bf16 v[196:199], a[108:111], a[60:63], v[196:199]
    ds_read_b128 a[88:91], v230 offset:32768
    s_waitcnt lgkmcnt(3)
    v_mfma_f32_16x16x32_bf16 v[8:11], a[112:115], v[168:171], v[8:11]
    v_exp_f32 v186, v186
    v_mfma_f32_16x16x32_bf16 v[12:15], a[116:119], v[168:171], v[12:15]
    ds_read_b128 a[92:95], v231 offset:32768
    v_mfma_f32_16x16x32_bf16 v[16:19], a[120:123], v[168:171], v[16:19]
    v_exp_f32 v187, v187
    v_mfma_f32_16x16x32_bf16 v[20:23], a[124:127], v[168:171], v[20:23]
    ds_read_b128 a[96:99], v228 offset:36864
    v_cvt_pk_bf16_f32 v185, v186, v187
    v_mfma_f32_16x16x32_bf16 v[24:27], a[128:131], v[168:171], v[24:27]
    v_exp_f32 v188, v188
    v_mfma_f32_16x16x32_bf16 v[28:31], a[132:135], v[168:171], v[28:31]
    ds_read_b128 a[100:103], v229 offset:36864
    v_mfma_f32_16x16x32_bf16 v[32:35], a[136:139], v[168:171], v[32:35]
    v_exp_f32 v189, v189
    v_mfma_f32_16x16x32_bf16 v[36:39], a[140:143], v[168:171], v[36:39]
    ds_read_b128 a[104:107], v230 offset:36864
    v_cvt_pk_bf16_f32 v186, v188, v189
    v_mfma_f32_16x16x32_bf16 a[148:151], a[144:147], v[168:171], a[148:151]
    v_exp_f32 v190, v190
    v_mfma_f32_16x16x32_bf16 v[40:43], a[112:115], v[176:179], v[40:43]
    ds_read_b128 a[108:111], v231 offset:36864
    v_mfma_f32_16x16x32_bf16 v[44:47], a[116:119], v[176:179], v[44:47]
    v_exp_f32 v191, v191
    v_mfma_f32_16x16x32_bf16 v[48:51], a[120:123], v[176:179], v[48:51]
    v_cvt_pk_bf16_f32 v187, v190, v191
    v_mfma_f32_16x16x32_bf16 v[52:55], a[124:127], v[176:179], v[52:55]
    v_exp_f32 v204, v204
    v_mfma_f32_16x16x32_bf16 v[56:59], a[128:131], v[176:179], v[56:59]
    v_mfma_f32_16x16x32_bf16 v[60:63], a[132:135], v[176:179], v[60:63]
    v_exp_f32 v205, v205
    v_mfma_f32_16x16x32_bf16 v[64:67], a[136:139], v[176:179], v[64:67]
    v_cvt_pk_bf16_f32 v202, v204, v205
    v_mfma_f32_16x16x32_bf16 v[68:71], a[140:143], v[176:179], v[68:71]
    v_exp_f32 v206, v206
    v_mfma_f32_16x16x32_bf16 a[152:155], a[144:147], v[176:179], a[152:155]
    s_waitcnt lgkmcnt(0)
    v_mfma_f32_16x16x32_bf16 v[168:171], a[80:83], a[0:3], v[208:211]
    s_waitcnt vmcnt(8)
    s_barrier
L_in1_2:
    v_mfma_f32_16x16x32_bf16 v[168:171], a[84:87], a[4:7], v[168:171]
    v_exp_f32 v207, v207
    v_mfma_f32_16x16x32_bf16 v[168:171], a[88:91], a[8:11], v[168:171]
    v_cvt_pk_bf16_f32 v203, v206, v207
    s_add_u32 m0, s30, 65536
    v_mfma_f32_16x16x32_bf16 v[168:171], a[92:95], a[12:15], v[168:171]
    v_exp_f32 v192, v192
    v_mfma_f32_16x16x32_bf16 v[172:175], a[96:99], a[0:3], v[208:211]
    buffer_load_dwordx4 v242, s[16:19], s31 offen nt lds
    v_mfma_f32_16x16x32_bf16 v[172:175], a[100:103], a[4:7], v[172:175]
    v_exp_f32 v193, v193
    v_mfma_f32_16x16x32_bf16 v[172:175], a[104:107], a[8:11], v[172:175]
    buffer_load_dwordx4 v243, s[16:19], s31 offen offset:1024 nt lds
    v_cvt_pk_bf16_f32 v192, v192, v193
    v_mfma_f32_16x16x32_bf16 v[172:175], a[108:111], a[12:15], v[172:175]
    v_exp_f32 v194, v194
    v_mfma_f32_16x16x32_bf16 v[176:179], a[80:83], a[16:19], v[212:215]
    s_add_u32 s31, s31, 16384
    v_mfma_f32_16x16x32_bf16 v[176:179], a[84:87], a[20:23], v[176:179]
    v_exp_f32 v195, v195
    v_mfma_f32_16x16x32_bf16 v[176:179], a[88:91], a[24:27], v[176:179]
    v_cvt_pk_bf16_f32 v193, v194, v195
    v_mfma_f32_16x16x32_bf16 v[176:179], a[92:95], a[28:31], v[176:179]
    v_exp_f32 v196, v196
    v_mfma_f32_16x16x32_bf16 v[180:183], a[96:99], a[16:19], v[212:215]
    s_cmp_lt_u32 s49, 90112
    s_cbranch_scc1 L_pf1_0_2
L_pf1_0_2r:
    v_mfma_f32_16x16x32_bf16 v[180:183], a[100:103], a[20:23], v[180:183]
    v_exp_f32 v197, v197
    v_mfma_f32_16x16x32_bf16 v[180:183], a[104:107], a[24:27], v[180:183]
    v_cvt_pk_bf16_f32 v194, v196, v197
    v_mfma_f32_16x16x32_bf16 v[180:183], a[108:111], a[28:31], v[180:183]
    v_exp_f32 v198, v198
    v_mfma_f32_16x16x32_bf16 v[136:139], a[112:115], v[200:203], v[136:139]
    v_mfma_f32_16x16x32_bf16 v[140:143], a[116:119], v[200:203], v[140:143]
    v_exp_f32 v199, v199
    v_mfma_f32_16x16x32_bf16 v[144:147], a[120:123], v[200:203], v[144:147]
    v_cvt_pk_bf16_f32 v195, v198, v199
    v_mfma_f32_16x16x32_bf16 v[148:151], a[124:127], v[200:203], v[148:151]
    v_mfma_f32_16x16x32_bf16 v[152:155], a[128:131], v[200:203], v[152:155]
    v_exp_f32 v168, v168
    v_mfma_f32_16x16x32_bf16 v[156:159], a[132:135], v[200:203], v[156:159]
    v_mfma_f32_16x16x32_bf16 v[160:163], a[136:139], v[200:203], v[160:163]
    v_exp_f32 v169, v169
    v_mfma_f32_16x16x32_bf16 v[164:167], a[140:143], v[200:203], v[164:167]
    v_cvt_pk_bf16_f32 v168, v168, v169
    v_mfma_f32_16x16x32_bf16 a[164:167], a[144:147], v[200:203], a[164:167]
    v_exp_f32 v170, v170
    v_mfma_f32_16x16x32_bf16 v[72:75], a[112:115], v[184:187], v[72:75]
    v_mfma_f32_16x16x32_bf16 v[104:107], a[112:115], v[192:195], v[104:107]
    v_exp_f32 v171, v171
    v_mfma_f32_16x16x32_bf16 v[76:79], a[116:119], v[184:187], v[76:79]
    ds_read_b64_tr_b16 a[112:113], v232 offset:32768
    v_cvt_pk_bf16_f32 v169, v170, v171
    v_mfma_f32_16x16x32_bf16 v[108:111], a[116:119], v[192:195], v[108:111]
    v_exp_f32 v172, v172
    v_mfma_f32_16x16x32_bf16 v[80:83], a[120:123], v[184:187], v[80:83]
    ds_read_b64_tr_b16 a[114:115], v232 offset:36864
    v_mfma_f32_16x16x32_bf16 v[112:115], a[120:123], v[192:195], v[112:115]
    v_exp_f32 v173, v173
    v_mfma_f32_16x16x32_bf16 v[84:87], a[124:127], v[184:187], v[84:87]
    ds_read_b64_tr_b16 a[116:117], v233 offset:32768
    v_cvt_pk_bf16_f32 v170, v172, v173
    v_mfma_f32_16x16x32_bf16 v[116:119], a[124:127], v[192:195], v[116:119]
    v_exp_f32 v174, v174
    v_mfma_f32_16x16x32_bf16 v[88:91], a[128:131], v[184:187], v[88:91]
    ds_read_b64_tr_b16 a[118:119], v233 offset:36864
    ds_read_b64_tr_b16 a[120:121], v234 offset:32768
    v_mfma_f32_16x16x32_bf16 v[120:123], a[128:131], v[192:195], v[120:123]
    v_exp_f32 v175, v175
    v_mfma_f32_16x16x32_bf16 v[92:95], a[132:135], v[184:187], v[92:95]
    ds_read_b64_tr_b16 a[122:123], v234 offset:36864
    v_cvt_pk_bf16_f32 v171, v174, v175
    v_mfma_f32_16x16x32_bf16 v[124:127], a[132:135], v[192:195], v[124:127]
    ds_read_b64_tr_b16 a[124:125], v235 offset:32768
    ds_read_b64_tr_b16 a[126:127], v235 offset:36864
    v_mfma_f32_16x16x32_bf16 v[96:99], a[136:139], v[184:187], v[96:99]
    v_exp_f32 v176, v176
    v_mfma_f32_16x16x32_bf16 v[128:131], a[136:139], v[192:195], v[128:131]
    ds_read_b64_tr_b16 a[128:129], v236 offset:32768
    ds_read_b64_tr_b16 a[130:131], v236 offset:36864
    v_mfma_f32_16x16x32_bf16 v[100:103], a[140:143], v[184:187], v[100:103]
    v_exp_f32 v177, v177
    v_mfma_f32_16x16x32_bf16 v[132:135], a[140:143], v[192:195], v[132:135]
    ds_read_b64_tr_b16 a[132:133], v237 offset:32768
    v_cvt_pk_bf16_f32 v176, v176, v177
    v_mfma_f32_16x16x32_bf16 a[156:159], a[144:147], v[184:187], a[156:159]
    v_exp_f32 v178, v178
    v_mfma_f32_16x16x32_bf16 a[160:163], a[144:147], v[192:195], a[160:163]
    ds_read_b64_tr_b16 a[134:135], v237 offset:36864
    s_add_u32 m0, s30, 8192
    v_mfma_f32_16x16x32_bf16 v[184:187], a[80:83], a[32:35], v[216:219]
    v_exp_f32 v179, v179
    v_mfma_f32_16x16x32_bf16 v[184:187], a[84:87], a[36:39], v[184:187]
    buffer_load_dwordx4 v240, s[12:15], s32 offen nt lds
    v_cvt_pk_bf16_f32 v177, v178, v179
    v_mfma_f32_16x16x32_bf16 v[184:187], a[88:91], a[40:43], v[184:187]
    v_exp_f32 v180, v180
    v_mfma_f32_16x16x32_bf16 v[184:187], a[92:95], a[44:47], v[184:187]
    buffer_load_dwordx4 v241, s[12:15], s32 offen offset:1024 nt lds
    ds_read_b64_tr_b16 a[136:137], v238 offset:32768
    v_mfma_f32_16x16x32_bf16 v[188:191], a[96:99], a[32:35], v[216:219]
    v_exp_f32 v181, v181
    v_mfma_f32_16x16x32_bf16 v[188:191], a[100:103], a[36:39], v[188:191]
    ds_read_b64_tr_b16 a[138:139], v238 offset:36864
    v_cvt_pk_bf16_f32 v178, v180, v181
    v_mfma_f32_16x16x32_bf16 v[188:191], a[104:107], a[40:43], v[188:191]
    v_exp_f32 v182, v182
    v_mfma_f32_16x16x32_bf16 v[188:191], a[108:111], a[44:47], v[188:191]
    ds_read_b64_tr_b16 a[140:141], v239 offset:32768
    ds_read_b64_tr_b16 a[142:143], v239 offset:36864
    v_mfma_f32_16x16x32_bf16 v[192:195], a[80:83], a[48:51], v[220:223]
    v_exp_f32 v183, v183
    v_mfma_f32_16x16x32_bf16 v[192:195], a[84:87], a[52:55], v[192:195]
    v_cvt_pk_bf16_f32 v179, v182, v183
    v_mfma_f32_16x16x32_bf16 v[192:195], a[88:91], a[56:59], v[192:195]
    ds_read_b128 a[80:83], v228 offset:40960
    v_mfma_f32_16x16x32_bf16 v[192:195], a[92:95], a[60:63], v[192:195]
    v_exp_f32 v184, v184
    v_mfma_f32_16x16x32_bf16 v[196:199], a[96:99], a[48:51], v[220:223]
    ds_read_b128 a[84:87], v229 offset:40960
    v_mfma_f32_16x16x32_bf16 v[196:199], a[100:103], a[52:55], v[196:199]
    v_exp_f32 v185, v185
    v_mfma_f32_16x16x32_bf16 v[196:199], a[104:107], a[56:59], v[196:199]
    v_cvt_pk_bf16_f32 v184, v184, v185
    v_mfma_f32_16x16x32_bf16 v[196:199], a[108:111], a[60:63], v[196:199]
    ds_read_b128 a[88:91], v230 offset:40960
    s_waitcnt lgkmcnt(3)
    v_mfma_f32_16x16x32_bf16 v[8:11], a[112:115], v[168:171], v[8:11]
    v_exp_f32 v186, v186
    v_mfma_f32_16x16x32_bf16 v[12:15], a[116:119], v[168:171], v[12:15]
    ds_read_b128 a[92:95], v231 offset:40960
    v_mfma_f32_16x16x32_bf16 v[16:19], a[120:123], v[168:171], v[16:19]
    v_exp_f32 v187, v187
    v_mfma_f32_16x16x32_bf16 v[20:23], a[124:127], v[168:171], v[20:23]
    ds_read_b128 a[96:99], v228 offset:45056
    v_cvt_pk_bf16_f32 v185, v186, v187
    v_mfma_f32_16x16x32_bf16 v[24:27], a[128:131], v[168:171], v[24:27]
    v_exp_f32 v188, v188
    v_mfma_f32_16x16x32_bf16 v[28:31], a[132:135], v[168:171], v[28:31]
    ds_read_b128 a[100:103], v229 offset:45056
    v_mfma_f32_16x16x32_bf16 v[32:35], a[136:139], v[168:171], v[32:35]
    v_exp_f32 v189, v189
    v_mfma_f32_16x16x32_bf16 v[36:39], a[140:143], v[168:171], v[36:39]
    ds_read_b128 a[104:107], v230 offset:45056
    v_cvt_pk_bf16_f32 v186, v188, v189
    v_mfma_f32_16x16x32_bf16 a[148:151], a[144:147], v[168:171], a[148:151]
    v_exp_f32 v190, v190
    v_mfma_f32_16x16x32_bf16 v[40:43], a[112:115], v[176:179], v[40:43]
    ds_read_b128 a[108:111], v231 offset:45056
    v_mfma_f32_16x16x32_bf16 v[44:47], a[116:119], v[176:179], v[44:47]
    v_exp_f32 v191, v191
    v_mfma_f32_16x16x32_bf16 v[48:51], a[120:123], v[176:179], v[48:51]
    v_cvt_pk_bf16_f32 v187, v190, v191
    v_mfma_f32_16x16x32_bf16 v[52:55], a[124:127], v[176:179], v[52:55]
    v_exp_f32 v192, v192
    v_mfma_f32_16x16x32_bf16 v[56:59], a[128:131], v[176:179], v[56:59]
    s_cmp_lt_u32 s49, 90112
    s_cbranch_scc1 L_pf1_1_2
L_pf1_1_2r:
    v_mfma_f32_16x16x32_bf16 v[60:63], a[132:135], v[176:179], v[60:63]
    v_exp_f32 v193, v193
    v_mfma_f32_16x16x32_bf16 v[64:67], a[136:139], v[176:179], v[64:67]
    v_cvt_pk_bf16_f32 v192, v192, v193
    v_mfma_f32_16x16x32_bf16 v[68:71], a[140:143], v[176:179], v[68:71]
    v_exp_f32 v194, v194
    v_mfma_f32_16x16x32_bf16 a[152:155], a[144:147], v[176:179], a[152:155]
    s_waitcnt lgkmcnt(0)
    v_mfma_f32_16x16x32_bf16 v[168:171], a[80:83], a[0:3], v[208:211]
    v_exp_f32 v195, v195
    v_mfma_f32_16x16x32_bf16 v[168:171], a[84:87], a[4:7], v[168:171]
    v_cvt_pk_bf16_f32 v193, v194, v195
    v_mfma_f32_16x16x32_bf16 v[168:171], a[88:91], a[8:11], v[168:171]
    v_exp_f32 v196, v196
    v_mfma_f32_16x16x32_bf16 v[168:171], a[92:95], a[12:15], v[168:171]
    v_mfma_f32_16x16x32_bf16 v[172:175], a[96:99], a[0:3], v[208:211]
    v_exp_f32 v197, v197
    v_mfma_f32_16x16x32_bf16 v[172:175], a[100:103], a[4:7], v[172:175]
    v_cvt_pk_bf16_f32 v194, v196, v197
    s_add_u32 m0, s30, 73728
    v_mfma_f32_16x16x32_bf16 v[172:175], a[104:107], a[8:11], v[172:175]
    v_exp_f32 v198, v198
    v_mfma_f32_16x16x32_bf16 v[172:175], a[108:111], a[12:15], v[172:175]
    buffer_load_dwordx4 v242, s[16:19], s32 offen nt lds
    v_mfma_f32_16x16x32_bf16 v[176:179], a[80:83], a[16:19], v[212:215]
    v_exp_f32 v199, v199
    v_mfma_f32_16x16x32_bf16 v[176:179], a[84:87], a[20:23], v[176:179]
    buffer_load_dwordx4 v243, s[16:19], s32 offen offset:1024 nt lds
    v_cvt_pk_bf16_f32 v195, v198, v199
    v_mfma_f32_16x16x32_bf16 v[176:179], a[88:91], a[24:27], v[176:179]
    s_add_u32 s32, s32, 16384
    v_mfma_f32_16x16x32_bf16 v[176:179], a[92:95], a[28:31], v[176:179]
    v_exp_f32 v168, v168
    v_mfma_f32_16x16x32_bf16 v[180:183], a[96:99], a[16:19], v[212:215]
    v_mfma_f32_16x16x32_bf16 v[180:183], a[100:103], a[20:23], v[180:183]
    v_exp_f32 v169, v169
    v_mfma_f32_16x16x32_bf16 v[180:183], a[104:107], a[24:27], v[180:183]
    v_cvt_pk_bf16_f32 v168, v168, v169
    v_mfma_f32_16x16x32_bf16 v[180:183], a[108:111], a[28:31], v[180:183]
    v_exp_f32 v170, v170
    v_mfma_f32_16x16x32_bf16 v[72:75], a[112:115], v[184:187], v[72:75]
    v_mfma_f32_16x16x32_bf16 v[104:107], a[112:115], v[192:195], v[104:107]
    v_exp_f32 v171, v171
    v_mfma_f32_16x16x32_bf16 v[76:79], a[116:119], v[184:187], v[76:79]
    ds_read_b64_tr_b16 a[112:113], v232 offset:40960
    v_cvt_pk_bf16_f32 v169, v170, v171
    v_mfma_f32_16x16x32_bf16 v[108:111], a[116:119], v[192:195], v[108:111]
    v_exp_f32 v172, v172
    v_mfma_f32_16x16x32_bf16 v[80:83], a[120:123], v[184:187], v[80:83]
    s_cmp_lt_u32 s49, 90112
    s_cbranch_scc1 L_pf1_2_2
L_pf1_2_2r:
    v_mfma_f32_16x16x32_bf16 v[112:115], a[120:123], v[192:195], v[112:115]
    v_exp_f32 v173, v173
    v_mfma_f32_16x16x32_bf16 v[84:87], a[124:127], v[184:187], v[84:87]
    ds_read_b64_tr_b16 a[114:115], v232 offset:45056
    v_cvt_pk_bf16_f32 v170, v172, v173
    v_mfma_f32_16x16x32_bf16 v[116:119], a[124:127], v[192:195], v[116:119]
    v_exp_f32 v174, v174
    v_mfma_f32_16x16x32_bf16 v[88:91], a[128:131], v[184:187], v[88:91]
    ds_read_b64_tr_b16 a[116:117], v233 offset:40960
    ds_read_b64_tr_b16 a[118:119], v233 offset:45056
    v_mfma_f32_16x16x32_bf16 v[120:123], a[128:131], v[192:195], v[120:123]
    v_exp_f32 v175, v175
    v_mfma_f32_16x16x32_bf16 v[92:95], a[132:135], v[184:187], v[92:95]
    v_cvt_pk_bf16_f32 v171, v174, v175
    v_mfma_f32_16x16x32_bf16 v[124:127], a[132:135], v[192:195], v[124:127]
    ds_read_b64_tr_b16 a[120:121], v234 offset:40960
    v_mfma_f32_16x16x32_bf16 v[96:99], a[136:139], v[184:187], v[96:99]
    v_exp_f32 v176, v176
    v_mfma_f32_16x16x32_bf16 v[128:131], a[136:139], v[192:195], v[128:131]
    ds_read_b64_tr_b16 a[122:123], v234 offset:45056
    v_mfma_f32_16x16x32_bf16 v[100:103], a[140:143], v[184:187], v[100:103]
    v_exp_f32 v177, v177
    v_mfma_f32_16x16x32_bf16 v[132:135], a[140:143], v[192:195], v[132:135]
    ds_read_b64_tr_b16 a[124:125], v235 offset:40960
    v_cvt_pk_bf16_f32 v176, v176, v177
    v_mfma_f32_16x16x32_bf16 a[156:159], a[144:147], v[184:187], a[156:159]
    v_exp_f32 v178, v178
    v_mfma_f32_16x16x32_bf16 a[160:163], a[144:147], v[192:195], a[160:163]
    ds_read_b64_tr_b16 a[126:127], v235 offset:45056
    v_mfma_f32_16x16x32_bf16 v[200:203], a[80:83], a[64:67], v[224:227]
    v_exp_f32 v179, v179
    v_mfma_f32_16x16x32_bf16 v[200:203], a[84:87], a[68:71], v[200:203]
    ds_read_b64_tr_b16 a[128:129], v236 offset:40960
    v_cvt_pk_bf16_f32 v177, v178, v179
    v_mfma_f32_16x16x32_bf16 v[200:203], a[88:91], a[72:75], v[200:203]
    v_exp_f32 v180, v180
    v_mfma_f32_16x16x32_bf16 v[200:203], a[92:95], a[76:79], v[200:203]
    ds_read_b64_tr_b16 a[130:131], v236 offset:45056
    v_mfma_f32_16x16x32_bf16 v[204:207], a[96:99], a[64:67], v[224:227]
    v_exp_f32 v181, v181
    v_mfma_f32_16x16x32_bf16 v[204:207], a[100:103], a[68:71], v[204:207]
    ds_read_b64_tr_b16 a[132:133], v237 offset:40960
    v_cvt_pk_bf16_f32 v178, v180, v181
    v_mfma_f32_16x16x32_bf16 v[204:207], a[104:107], a[72:75], v[204:207]
    v_exp_f32 v182, v182
    v_mfma_f32_16x16x32_bf16 v[204:207], a[108:111], a[76:79], v[204:207]
    ds_read_b64_tr_b16 a[134:135], v237 offset:45056
    v_mfma_f32_16x16x32_bf16 v[184:187], a[80:83], a[32:35], v[216:219]
    v_exp_f32 v183, v183
    v_mfma_f32_16x16x32_bf16 v[184:187], a[84:87], a[36:39], v[184:187]
    v_cvt_pk_bf16_f32 v179, v182, v183
    s_add_u32 m0, s30, 16384
    v_mfma_f32_16x16x32_bf16 v[184:187], a[88:91], a[40:43], v[184:187]
    buffer_load_dwordx4 v240, s[12:15], s31 offen nt lds
    ds_read_b64_tr_b16 a[136:137], v238 offset:40960
    v_mfma_f32_16x16x32_bf16 v[184:187], a[92:95], a[44:47], v[184:187]
    v_exp_f32 v200, v200
    v_mfma_f32_16x16x32_bf16 v[188:191], a[96:99], a[32:35], v[216:219]
    buffer_load_dwordx4 v241, s[12:15], s31 offen offset:1024 nt lds
    ds_read_b64_tr_b16 a[138:139], v238 offset:45056
    v_mfma_f32_16x16x32_bf16 v[188:191], a[100:103], a[36:39], v[188:191]
    v_exp_f32 v201, v201
    v_mfma_f32_16x16x32_bf16 v[188:191], a[104:107], a[40:43], v[188:191]
    ds_read_b64_tr_b16 a[140:141], v239 offset:40960
    v_cvt_pk_bf16_f32 v200, v200, v201
    v_mfma_f32_16x16x32_bf16 v[188:191], a[108:111], a[44:47], v[188:191]
    v_exp_f32 v202, v202
    v_mfma_f32_16x16x32_bf16 v[192:195], a[80:83], a[48:51], v[220:223]
    ds_read_b64_tr_b16 a[142:143], v239 offset:45056
    v_mfma_f32_16x16x32_bf16 v[192:195], a[84:87], a[52:55], v[192:195]
    v_exp_f32 v203, v203
    v_mfma_f32_16x16x32_bf16 v[192:195], a[88:91], a[56:59], v[192:195]
    ds_read_b128 a[80:83], v228 offset:49152
    v_cvt_pk_bf16_f32 v201, v202, v203
    v_mfma_f32_16x16x32_bf16 v[192:195], a[92:95], a[60:63], v[192:195]
    v_exp_f32 v184, v184
    v_mfma_f32_16x16x32_bf16 v[196:199], a[96:99], a[48:51], v[220:223]
    ds_read_b128 a[84:87], v229 offset:49152
    v_mfma_f32_16x16x32_bf16 v[196:199], a[100:103], a[52:55], v[196:199]
    v_exp_f32 v185, v185
    v_mfma_f32_16x16x32_bf16 v[196:199], a[104:107], a[56:59], v[196:199]
    v_cvt_pk_bf16_f32 v184, v184, v185
    v_mfma_f32_16x16x32_bf16 v[196:199], a[108:111], a[60:63], v[196:199]
    ds_read_b128 a[88:91], v230 offset:49152
    s_waitcnt lgkmcnt(3)
    v_mfma_f32_16x16x32_bf16 v[8:11], a[112:115], v[168:171], v[8:11]
    v_exp_f32 v186, v186
    v_mfma_f32_16x16x32_bf16 v[12:15], a[116:119], v[168:171], v[12:15]
    ds_read_b128 a[92:95], v231 offset:49152
    v_mfma_f32_16x16x32_bf16 v[16:19], a[120:123], v[168:171], v[16:19]
    v_exp_f32 v187, v187
    v_mfma_f32_16x16x32_bf16 v[20:23], a[124:127], v[168:171], v[20:23]
    ds_read_b128 a[96:99], v228 offset:53248
    v_cvt_pk_bf16_f32 v185, v186, v187
    v_mfma_f32_16x16x32_bf16 v[24:27], a[128:131], v[168:171], v[24:27]
    v_exp_f32 v188, v188
    v_mfma_f32_16x16x32_bf16 v[28:31], a[132:135], v[168:171], v[28:31]
    ds_read_b128 a[100:103], v229 offset:53248
    v_mfma_f32_16x16x32_bf16 v[32:35], a[136:139], v[168:171], v[32:35]
    v_exp_f32 v189, v189
    v_mfma_f32_16x16x32_bf16 v[36:39], a[140:143], v[168:171], v[36:39]
    ds_read_b128 a[104:107], v230 offset:53248
    v_cvt_pk_bf16_f32 v186, v188, v189
    v_mfma_f32_16x16x32_bf16 a[148:151], a[144:147], v[168:171], a[148:151]
    v_exp_f32 v190, v190
    v_mfma_f32_16x16x32_bf16 v[40:43], a[112:115], v[176:179], v[40:43]
    ds_read_b128 a[108:111], v231 offset:53248
    v_mfma_f32_16x16x32_bf16 v[44:47], a[116:119], v[176:179], v[44:47]
    v_exp_f32 v191, v191
    v_mfma_f32_16x16x32_bf16 v[48:51], a[120:123], v[176:179], v[48:51]
    v_cvt_pk_bf16_f32 v187, v190, v191
    v_mfma_f32_16x16x32_bf16 v[52:55], a[124:127], v[176:179], v[52:55]
    v_exp_f32 v204, v204
    v_mfma_f32_16x16x32_bf16 v[56:59], a[128:131], v[176:179], v[56:59]
    v_mfma_f32_16x16x32_bf16 v[60:63], a[132:135], v[176:179], v[60:63]
    v_exp_f32 v205, v205
    v_mfma_f32_16x16x32_bf16 v[64:67], a[136:139], v[176:179], v[64:67]
    v_cvt_pk_bf16_f32 v202, v204, v205
    v_mfma_f32_16x16x32_bf16 v[68:71], a[140:143], v[176:179], v[68:71]
    v_exp_f32 v206, v206
    v_mfma_f32_16x16x32_bf16 a[152:155], a[144:147], v[176:179], a[152:155]
    s_waitcnt lgkmcnt(0)
    v_mfma_f32_16x16x32_bf16 v[168:171], a[80:83], a[0:3], v[208:211]
    s_waitcnt vmcnt(8)
    s_barrier
L_in1_3:
    v_mfma_f32_16x16x32_bf16 v[168:171], a[84:87], a[4:7], v[168:171]
    v_exp_f32 v207, v207
    v_mfma_f32_16x16x32_bf16 v[168:171], a[88:91], a[8:11], v[168:171]
    v_cvt_pk_bf16_f32 v203, v206, v207
    s_add_u32 m0, s30, 81920
    v_mfma_f32_16x16x32_bf16 v[168:171], a[92:95], a[12:15], v[168:171]
    v_exp_f32 v192, v192
    v_mfma_f32_16x16x32_bf16 v[172:175], a[96:99], a[0:3], v[208:211]
    buffer_load_dwordx4 v242, s[16:19], s31 offen nt lds
    v_mfma_f32_16x16x32_bf16 v[172:175], a[100:103], a[4:7], v[172:175]
    v_exp_f32 v193, v193
    v_mfma_f32_16x16x32_bf16 v[172:175], a[104:107], a[8:11], v[172:175]
    buffer_load_dwordx4 v243, s[16:19], s31 offen offset:1024 nt lds
    v_cvt_pk_bf16_f32 v192, v192, v193
    v_mfma_f32_16x16x32_bf16 v[172:175], a[108:111], a[12:15], v[172:175]
    v_exp_f32 v194, v194
    v_mfma_f32_16x16x32_bf16 v[176:179], a[80:83], a[16:19], v[212:215]
    s_add_u32 s31, s31, 16384
    v_mfma_f32_16x16x32_bf16 v[176:179], a[84:87], a[20:23], v[176:179]
    v_exp_f32 v195, v195
    v_mfma_f32_16x16x32_bf16 v[176:179], a[88:91], a[24:27], v[176:179]
    v_cvt_pk_bf16_f32 v193, v194, v195
    v_mfma_f32_16x16x32_bf16 v[176:179], a[92:95], a[28:31], v[176:179]
    v_exp_f32 v196, v196
    v_mfma_f32_16x16x32_bf16 v[180:183], a[96:99], a[16:19], v[212:215]
    s_cmp_lt_u32 s49, 90112
    s_cbranch_scc1 L_pf1_0_3
L_pf1_0_3r:
    v_mfma_f32_16x16x32_bf16 v[180:183], a[100:103], a[20:23], v[180:183]
    v_exp_f32 v197, v197
    v_mfma_f32_16x16x32_bf16 v[180:183], a[104:107], a[24:27], v[180:183]
    v_cvt_pk_bf16_f32 v194, v196, v197
    v_mfma_f32_16x16x32_bf16 v[180:183], a[108:111], a[28:31], v[180:183]
    v_exp_f32 v198, v198
    v_mfma_f32_16x16x32_bf16 v[136:139], a[112:115], v[200:203], v[136:139]
    v_mfma_f32_16x16x32_bf16 v[140:143], a[116:119], v[200:203], v[140:143]
    v_exp_f32 v199, v199
    v_mfma_f32_16x16x32_bf16 v[144:147], a[120:123], v[200:203], v[144:147]
    v_cvt_pk_bf16_f32 v195, v198, v199
    v_mfma_f32_16x16x32_bf16 v[148:151], a[124:127], v[200:203], v[148:151]
    v_mfma_f32_16x16x32_bf16 v[152:155], a[128:131], v[200:203], v[152:155]
    v_exp_f32 v168, v168
    v_mfma_f32_16x16x32_bf16 v[156:159], a[132:135], v[200:203], v[156:159]
    v_mfma_f32_16x16x32_bf16 v[160:163], a[136:139], v[200:203], v[160:163]
    v_exp_f32 v169, v169
    v_mfma_f32_16x16x32_bf16 v[164:167], a[140:143], v[200:203], v[164:167]
    v_cvt_pk_bf16_f32 v168, v168, v169
    v_mfma_f32_16x16x32_bf16 a[164:167], a[144:147], v[200:203], a[164:167]
    v_exp_f32 v170, v170
    v_mfma_f32_16x16x32_bf16 v[72:75], a[112:115], v[184:187], v[72:75]
    v_mfma_f32_16x16x32_bf16 v[104:107], a[112:115], v[192:195], v[104:107]
    v_exp_f32 v171, v171
    v_mfma_f32_16x16x32_bf16 v[76:79], a[116:119], v[184:187], v[76:79]
    ds_read_b64_tr_b16 a[112:113], v232 offset:49152
    v_cvt_pk_bf16_f32 v169, v170, v171
    v_mfma_f32_16x16x32_bf16 v[108:111], a[116:119], v[192:195], v[108:111]
    v_exp_f32 v172, v172
    v_mfma_f32_16x16x32_bf16 v[80:83], a[120:123], v[184:187], v[80:83]
    ds_read_b64_tr_b16 a[114:115], v232 offset:53248
    v_mfma_f32_16x16x32_bf16 v[112:115], a[120:123], v[192:195], v[112:115]
    v_exp_f32 v173, v173
    v_mfma_f32_16x16x32_bf16 v[84:87], a[124:127], v[184:187], v[84:87]
    ds_read_b64_tr_b16 a[116:117], v233 offset:49152
    v_cvt_pk_bf16_f32 v170, v172, v173
    v_mfma_f32_16x16x32_bf16 v[116:119], a[124:127], v[192:195], v[116:119]
    v_exp_f32 v174, v174
    v_mfma_f32_16x16x32_bf16 v[88:91], a[128:131], v[184:187], v[88:91]
    ds_read_b64_tr_b16 a[118:119], v233 offset:53248
    ds_read_b64_tr_b16 a[120:121], v234 offset:49152
    v_mfma_f32_16x16x32_bf16 v[120:123], a[128:131], v[192:195], v[120:123]
    v_exp_f32 v175, v175
    v_mfma_f32_16x16x32_bf16 v[92:95], a[132:135], v[184:187], v[92:95]
    ds_read_b64_tr_b16 a[122:123], v234 offset:53248
    v_cvt_pk_bf16_f32 v171, v174, v175
    v_mfma_f32_16x16x32_bf16 v[124:127], a[132:135], v[192:195], v[124:127]
    ds_read_b64_tr_b16 a[124:125], v235 offset:49152
    ds_read_b64_tr_b16 a[126:127], v235 offset:53248
    v_mfma_f32_16x16x32_bf16 v[96:99], a[136:139], v[184:187], v[96:99]
    v_exp_f32 v176, v176
    v_mfma_f32_16x16x32_bf16 v[128:131], a[136:139], v[192:195], v[128:131]
    ds_read_b64_tr_b16 a[128:129], v236 offset:49152
    ds_read_b64_tr_b16 a[130:131], v236 offset:53248
    v_mfma_f32_16x16x32_bf16 v[100:103], a[140:143], v[184:187], v[100:103]
    v_exp_f32 v177, v177
    v_mfma_f32_16x16x32_bf16 v[132:135], a[140:143], v[192:195], v[132:135]
    ds_read_b64_tr_b16 a[132:133], v237 offset:49152
    v_cvt_pk_bf16_f32 v176, v176, v177
    v_mfma_f32_16x16x32_bf16 a[156:159], a[144:147], v[184:187], a[156:159]
    v_exp_f32 v178, v178
    v_mfma_f32_16x16x32_bf16 a[160:163], a[144:147], v[192:195], a[160:163]
    ds_read_b64_tr_b16 a[134:135], v237 offset:53248
    s_add_u32 m0, s30, 24576
    v_mfma_f32_16x16x32_bf16 v[184:187], a[80:83], a[32:35], v[216:219]
    v_exp_f32 v179, v179
    v_mfma_f32_16x16x32_bf16 v[184:187], a[84:87], a[36:39], v[184:187]
    buffer_load_dwordx4 v240, s[12:15], s32 offen nt lds
    v_cvt_pk_bf16_f32 v177, v178, v179
    v_mfma_f32_16x16x32_bf16 v[184:187], a[88:91], a[40:43], v[184:187]
    v_exp_f32 v180, v180
    v_mfma_f32_16x16x32_bf16 v[184:187], a[92:95], a[44:47], v[184:187]
    buffer_load_dwordx4 v241, s[12:15], s32 offen offset:1024 nt lds
    ds_read_b64_tr_b16 a[136:137], v238 offset:49152
    v_mfma_f32_16x16x32_bf16 v[188:191], a[96:99], a[32:35], v[216:219]
    v_exp_f32 v181, v181
    v_mfma_f32_16x16x32_bf16 v[188:191], a[100:103], a[36:39], v[188:191]
    ds_read_b64_tr_b16 a[138:139], v238 offset:53248
    v_cvt_pk_bf16_f32 v178, v180, v181
    v_mfma_f32_16x16x32_bf16 v[188:191], a[104:107], a[40:43], v[188:191]
    v_exp_f32 v182, v182
    v_mfma_f32_16x16x32_bf16 v[188:191], a[108:111], a[44:47], v[188:191]
    ds_read_b64_tr_b16 a[140:141], v239 offset:49152
    ds_read_b64_tr_b16 a[142:143], v239 offset:53248
    v_mfma_f32_16x16x32_bf16 v[192:195], a[80:83], a[48:51], v[220:223]
    v_exp_f32 v183, v183
    v_mfma_f32_16x16x32_bf16 v[192:195], a[84:87], a[52:55], v[192:195]
    v_cvt_pk_bf16_f32 v179, v182, v183
    v_mfma_f32_16x16x32_bf16 v[192:195], a[88:91], a[56:59], v[192:195]
    ds_read_b128 a[80:83], v228 offset:57344
    v_mfma_f32_16x16x32_bf16 v[192:195], a[92:95], a[60:63], v[192:195]
    v_exp_f32 v184, v184
    v_mfma_f32_16x16x32_bf16 v[196:199], a[96:99], a[48:51], v[220:223]
    ds_read_b128 a[84:87], v229 offset:57344
    v_mfma_f32_16x16x32_bf16 v[196:199], a[100:103], a[52:55], v[196:199]
    v_exp_f32 v185, v185
    v_mfma_f32_16x16x32_bf16 v[196:199], a[104:107], a[56:59], v[196:199]
    v_cvt_pk_bf16_f32 v184, v184, v185
    v_mfma_f32_16x16x32_bf16 v[196:199], a[108:111], a[60:63], v[196:199]
    ds_read_b128 a[88:91], v230 offset:57344
    s_waitcnt lgkmcnt(3)
    v_mfma_f32_16x16x32_bf16 v[8:11], a[112:115], v[168:171], v[8:11]
    v_exp_f32 v186, v186
    v_mfma_f32_16x16x32_bf16 v[12:15], a[116:119], v[168:171], v[12:15]
    ds_read_b128 a[92:95], v231 offset:57344
    v_mfma_f32_16x16x32_bf16 v[16:19], a[120:123], v[168:171], v[16:19]
    v_exp_f32 v187, v187
    v_mfma_f32_16x16x32_bf16 v[20:23], a[124:127], v[168:171], v[20:23]
    ds_read_b128 a[96:99], v228 offset:61440
    v_cvt_pk_bf16_f32 v185, v186, v187
    v_mfma_f32_16x16x32_bf16 v[24:27], a[128:131], v[168:171], v[24:27]
    v_exp_f32 v188, v188
    v_mfma_f32_16x16x32_bf16 v[28:31], a[132:135], v[168:171], v[28:31]
    ds_read_b128 a[100:103], v229 offset:61440
    v_mfma_f32_16x16x32_bf16 v[32:35], a[136:139], v[168:171], v[32:35]
    v_exp_f32 v189, v189
    v_mfma_f32_16x16x32_bf16 v[36:39], a[140:143], v[168:171], v[36:39]
    ds_read_b128 a[104:107], v230 offset:61440
    v_cvt_pk_bf16_f32 v186, v188, v189
    v_mfma_f32_16x16x32_bf16 a[148:151], a[144:147], v[168:171], a[148:151]
    v_exp_f32 v190, v190
    v_mfma_f32_16x16x32_bf16 v[40:43], a[112:115], v[176:179], v[40:43]
    ds_read_b128 a[108:111], v231 offset:61440
    v_mfma_f32_16x16x32_bf16 v[44:47], a[116:119], v[176:179], v[44:47]
    v_exp_f32 v191, v191
    v_mfma_f32_16x16x32_bf16 v[48:51], a[120:123], v[176:179], v[48:51]
    v_cvt_pk_bf16_f32 v187, v190, v191
    v_mfma_f32_16x16x32_bf16 v[52:55], a[124:127], v[176:179], v[52:55]
    v_exp_f32 v192, v192
    v_mfma_f32_16x16x32_bf16 v[56:59], a[128:131], v[176:179], v[56:59]
    s_cmp_lt_u32 s49, 90112
    s_cbranch_scc1 L_pf1_1_3
L_pf1_1_3r:
    v_mfma_f32_16x16x32_bf16 v[60:63], a[132:135], v[176:179], v[60:63]
    v_exp_f32 v193, v193
    v_mfma_f32_16x16x32_bf16 v[64:67], a[136:139], v[176:179], v[64:67]
    v_cvt_pk_bf16_f32 v192, v192, v193
    v_mfma_f32_16x16x32_bf16 v[68:71], a[140:143], v[176:179], v[68:71]
    v_exp_f32 v194, v194
    v_mfma_f32_16x16x32_bf16 a[152:155], a[144:147], v[176:179], a[152:155]
    s_waitcnt lgkmcnt(0)
    v_mfma_f32_16x16x32_bf16 v[168:171], a[80:83], a[0:3], v[208:211]
    v_exp_f32 v195, v195
    v_mfma_f32_16x16x32_bf16 v[168:171], a[84:87], a[4:7], v[168:171]
    v_cvt_pk_bf16_f32 v193, v194, v195
    v_mfma_f32_16x16x32_bf16 v[168:171], a[88:91], a[8:11], v[168:171]
    v_exp_f32 v196, v196
    v_mfma_f32_16x16x32_bf16 v[168:171], a[92:95], a[12:15], v[168:171]
    v_mfma_f32_16x16x32_bf16 v[172:175], a[96:99], a[0:3], v[208:211]
    v_exp_f32 v197, v197
    v_mfma_f32_16x16x32_bf16 v[172:175], a[100:103], a[4:7], v[172:175]
    v_cvt_pk_bf16_f32 v194, v196, v197
    s_add_u32 m0, s30, 90112
    v_mfma_f32_16x16x32_bf16 v[172:175], a[104:107], a[8:11], v[172:175]
    v_exp_f32 v198, v198
    v_mfma_f32_16x16x32_bf16 v[172:175], a[108:111], a[12:15], v[172:175]
    buffer_load_dwordx4 v242, s[16:19], s32 offen nt lds
    v_mfma_f32_16x16x32_bf16 v[176:179], a[80:83], a[16:19], v[212:215]
    v_exp_f32 v199, v199
    v_mfma_f32_16x16x32_bf16 v[176:179], a[84:87], a[20:23], v[176:179]
    buffer_load_dwordx4 v243, s[16:19], s32 offen offset:1024 nt lds
    v_cvt_pk_bf16_f32 v195, v198, v199
    v_mfma_f32_16x16x32_bf16 v[176:179], a[88:91], a[24:27], v[176:179]
    s_add_u32 s32, s32, 16384
    v_mfma_f32_16x16x32_bf16 v[176:179], a[92:95], a[28:31], v[176:179]
    v_exp_f32 v168, v168
    v_mfma_f32_16x16x32_bf16 v[180:183], a[96:99], a[16:19], v[212:215]
    v_mfma_f32_16x16x32_bf16 v[180:183], a[100:103], a[20:23], v[180:183]
    v_exp_f32 v169, v169
    v_mfma_f32_16x16x32_bf16 v[180:183], a[104:107], a[24:27], v[180:183]
    v_cvt_pk_bf16_f32 v168, v168, v169
    v_mfma_f32_16x16x32_bf16 v[180:183], a[108:111], a[28:31], v[180:183]
    v_exp_f32 v170, v170
    v_mfma_f32_16x16x32_bf16 v[72:75], a[112:115], v[184:187], v[72:75]
    v_mfma_f32_16x16x32_bf16 v[104:107], a[112:115], v[192:195], v[104:107]
    v_exp_f32 v171, v171
    v_mfma_f32_16x16x32_bf16 v[76:79], a[116:119], v[184:187], v[76:79]
    ds_read_b64_tr_b16 a[112:113], v232 offset:57344
    v_cvt_pk_bf16_f32 v169, v170, v171
    v_mfma_f32_16x16x32_bf16 v[108:111], a[116:119], v[192:195], v[108:111]
    v_exp_f32 v172, v172
    v_mfma_f32_16x16x32_bf16 v[80:83], a[120:123], v[184:187], v[80:83]
    s_cmp_lt_u32 s49, 90112
    s_cbranch_scc1 L_pf1_2_3
L_pf1_2_3r:
    v_mfma_f32_16x16x32_bf16 v[112:115], a[120:123], v[192:195], v[112:115]
    v_exp_f32 v173, v173
    v_mfma_f32_16x16x32_bf16 v[84:87], a[124:127], v[184:187], v[84:87]
    ds_read_b64_tr_b16 a[114:115], v232 offset:61440
    v_cvt_pk_bf16_f32 v170, v172, v173
    v_mfma_f32_16x16x32_bf16 v[116:119], a[124:127], v[192:195], v[116:119]
    v_exp_f32 v174, v174
    v_mfma_f32_16x16x32_bf16 v[88:91], a[128:131], v[184:187], v[88:91]
    ds_read_b64_tr_b16 a[116:117], v233 offset:57344
    ds_read_b64_tr_b16 a[118:119], v233 offset:61440
    v_mfma_f32_16x16x32_bf16 v[120:123], a[128:131], v[192:195], v[120:123]
    v_exp_f32 v175, v175
    v_mfma_f32_16x16x32_bf16 v[92:95], a[132:135], v[184:187], v[92:95]
    v_cvt_pk_bf16_f32 v171, v174, v175
    v_mfma_f32_16x16x32_bf16 v[124:127], a[132:135], v[192:195], v[124:127]
    ds_read_b64_tr_b16 a[120:121], v234 offset:57344
    v_mfma_f32_16x16x32_bf16 v[96:99], a[136:139], v[184:187], v[96:99]
    v_exp_f32 v176, v176
    v_mfma_f32_16x16x32_bf16 v[128:131], a[136:139], v[192:195], v[128:131]
    ds_read_b64_tr_b16 a[122:123], v234 offset:61440
    v_mfma_f32_16x16x32_bf16 v[100:103], a[140:143], v[184:187], v[100:103]
    v_exp_f32 v177, v177
    v_mfma_f32_16x16x32_bf16 v[132:135], a[140:143], v[192:195], v[132:135]
    ds_read_b64_tr_b16 a[124:125], v235 offset:57344
    v_cvt_pk_bf16_f32 v176, v176, v177
    v_mfma_f32_16x16x32_bf16 a[156:159], a[144:147], v[184:187], a[156:159]
    v_exp_f32 v178, v178
    v_mfma_f32_16x16x32_bf16 a[160:163], a[144:147], v[192:195], a[160:163]
    ds_read_b64_tr_b16 a[126:127], v235 offset:61440
    v_mfma_f32_16x16x32_bf16 v[200:203], a[80:83], a[64:67], v[224:227]
    v_exp_f32 v179, v179
    v_mfma_f32_16x16x32_bf16 v[200:203], a[84:87], a[68:71], v[200:203]
    ds_read_b64_tr_b16 a[128:129], v236 offset:57344
    v_cvt_pk_bf16_f32 v177, v178, v179
    v_mfma_f32_16x16x32_bf16 v[200:203], a[88:91], a[72:75], v[200:203]
    v_exp_f32 v180, v180
    v_mfma_f32_16x16x32_bf16 v[200:203], a[92:95], a[76:79], v[200:203]
    ds_read_b64_tr_b16 a[130:131], v236 offset:61440
    v_mfma_f32_16x16x32_bf16 v[204:207], a[96:99], a[64:67], v[224:227]
    v_exp_f32 v181, v181
    v_mfma_f32_16x16x32_bf16 v[204:207], a[100:103], a[68:71], v[204:207]
    ds_read_b64_tr_b16 a[132:133], v237 offset:57344
    v_cvt_pk_bf16_f32 v178, v180, v181
    v_mfma_f32_16x16x32_bf16 v[204:207], a[104:107], a[72:75], v[204:207]
    v_exp_f32 v182, v182
    v_mfma_f32_16x16x32_bf16 v[204:207], a[108:111], a[76:79], v[204:207]
    ds_read_b64_tr_b16 a[134:135], v237 offset:61440
    v_mfma_f32_16x16x32_bf16 v[184:187], a[80:83], a[32:35], v[216:219]
    v_exp_f32 v183, v183
    v_mfma_f32_16x16x32_bf16 v[184:187], a[84:87], a[36:39], v[184:187]
    v_cvt_pk_bf16_f32 v179, v182, v183
    s_add_u32 m0, s30, 32768
    v_mfma_f32_16x16x32_bf16 v[184:187], a[88:91], a[40:43], v[184:187]
    buffer_load_dwordx4 v240, s[12:15], s31 offen nt lds
    ds_read_b64_tr_b16 a[136:137], v238 offset:57344
    v_mfma_f32_16x16x32_bf16 v[184:187], a[92:95], a[44:47], v[184:187]
    v_exp_f32 v200, v200
    v_mfma_f32_16x16x32_bf16 v[188:191], a[96:99], a[32:35], v[216:219]
    buffer_load_dwordx4 v241, s[12:15], s31 offen offset:1024 nt lds
    ds_read_b64_tr_b16 a[138:139], v238 offset:61440
    v_mfma_f32_16x16x32_bf16 v[188:191], a[100:103], a[36:39], v[188:191]
    v_exp_f32 v201, v201
    v_mfma_f32_16x16x32_bf16 v[188:191], a[104:107], a[40:43], v[188:191]
    ds_read_b64_tr_b16 a[140:141], v239 offset:57344
    v_cvt_pk_bf16_f32 v200, v200, v201
    v_mfma_f32_16x16x32_bf16 v[188:191], a[108:111], a[44:47], v[188:191]
    v_exp_f32 v202, v202
    v_mfma_f32_16x16x32_bf16 v[192:195], a[80:83], a[48:51], v[220:223]
    ds_read_b64_tr_b16 a[142:143], v239 offset:61440
    v_mfma_f32_16x16x32_bf16 v[192:195], a[84:87], a[52:55], v[192:195]
    v_exp_f32 v203, v203
    v_mfma_f32_16x16x32_bf16 v[192:195], a[88:91], a[56:59], v[192:195]
    ds_read_b128 a[80:83], v228 offset:0
    v_cvt_pk_bf16_f32 v201, v202, v203
    v_mfma_f32_16x16x32_bf16 v[192:195], a[92:95], a[60:63], v[192:195]
    v_exp_f32 v184, v184
    v_mfma_f32_16x16x32_bf16 v[196:199], a[96:99], a[48:51], v[220:223]
    ds_read_b128 a[84:87], v229 offset:0
    v_mfma_f32_16x16x32_bf16 v[196:199], a[100:103], a[52:55], v[196:199]
    v_exp_f32 v185, v185
    v_mfma_f32_16x16x32_bf16 v[196:199], a[104:107], a[56:59], v[196:199]
    v_cvt_pk_bf16_f32 v184, v184, v185
    v_mfma_f32_16x16x32_bf16 v[196:199], a[108:111], a[60:63], v[196:199]
    ds_read_b128 a[88:91], v230 offset:0
    s_waitcnt lgkmcnt(3)
    v_mfma_f32_16x16x32_bf16 v[8:11], a[112:115], v[168:171], v[8:11]
    v_exp_f32 v186, v186
    v_mfma_f32_16x16x32_bf16 v[12:15], a[116:119], v[168:171], v[12:15]
    ds_read_b128 a[92:95], v231 offset:0
    v_mfma_f32_16x16x32_bf16 v[16:19], a[120:123], v[168:171], v[16:19]
    v_exp_f32 v187, v187
    v_mfma_f32_16x16x32_bf16 v[20:23], a[124:127], v[168:171], v[20:23]
    ds_read_b128 a[96:99], v228 offset:4096
    v_cvt_pk_bf16_f32 v185, v186, v187
    v_mfma_f32_16x16x32_bf16 v[24:27], a[128:131], v[168:171], v[24:27]
    v_exp_f32 v188, v188
    v_mfma_f32_16x16x32_bf16 v[28:31], a[132:135], v[168:171], v[28:31]
    ds_read_b128 a[100:103], v229 offset:4096
    v_mfma_f32_16x16x32_bf16 v[32:35], a[136:139], v[168:171], v[32:35]
    v_exp_f32 v189, v189
    v_mfma_f32_16x16x32_bf16 v[36:39], a[140:143], v[168:171], v[36:39]
    ds_read_b128 a[104:107], v230 offset:4096
    v_cvt_pk_bf16_f32 v186, v188, v189
    v_mfma_f32_16x16x32_bf16 a[148:151], a[144:147], v[168:171], a[148:151]
    v_exp_f32 v190, v190
    v_mfma_f32_16x16x32_bf16 v[40:43], a[112:115], v[176:179], v[40:43]
    ds_read_b128 a[108:111], v231 offset:4096
    v_mfma_f32_16x16x32_bf16 v[44:47], a[116:119], v[176:179], v[44:47]
    v_exp_f32 v191, v191
    v_mfma_f32_16x16x32_bf16 v[48:51], a[120:123], v[176:179], v[48:51]
    v_cvt_pk_bf16_f32 v187, v190, v191
    v_mfma_f32_16x16x32_bf16 v[52:55], a[124:127], v[176:179], v[52:55]
    v_exp_f32 v204, v204
    v_mfma_f32_16x16x32_bf16 v[56:59], a[128:131], v[176:179], v[56:59]
    v_mfma_f32_16x16x32_bf16 v[60:63], a[132:135], v[176:179], v[60:63]
    v_exp_f32 v205, v205
    v_mfma_f32_16x16x32_bf16 v[64:67], a[136:139], v[176:179], v[64:67]
    v_cvt_pk_bf16_f32 v202, v204, v205
    v_mfma_f32_16x16x32_bf16 v[68:71], a[140:143], v[176:179], v[68:71]
    v_exp_f32 v206, v206
    v_mfma_f32_16x16x32_bf16 a[152:155], a[144:147], v[176:179], a[152:155]
    s_cmp_lt_u32 s31, 557056
    s_cbranch_scc1 L_loop1
    v_accvgpr_read_b32 v208, a168
    v_accvgpr_read_b32 v209, a169
    v_exp_f32 v207, v207
    v_accvgpr_read_b32 v210, a170
    v_accvgpr_read_b32 v211, a171
    v_cvt_pk_bf16_f32 v203, v206, v207
    v_accvgpr_read_b32 v212, a172
    v_accvgpr_read_b32 v213, a173
    v_exp_f32 v192, v192
    v_accvgpr_read_b32 v214, a174
    v_accvgpr_read_b32 v215, a175
    v_exp_f32 v193, v193
    v_accvgpr_read_b32 v216, a176
    v_accvgpr_read_b32 v217, a177
    v_cvt_pk_bf16_f32 v192, v192, v193
    v_accvgpr_read_b32 v218, a178
    v_accvgpr_read_b32 v219, a179
    v_exp_f32 v194, v194
    v_mov_b32 v246, 0
    v_mov_b32 v247, 0
    v_exp_f32 v195, v195
    v_accvgpr_read_b32 v250, a148
    v_accvgpr_read_b32 v251, a152
    v_cvt_pk_bf16_f32 v193, v194, v195
    v_mov_b32 v224, v250
    v_mov_b32 v225, v251
    v_exp_f32 v196, v196
    s_nop 1
    v_permlane16_swap_b32 v250, v224
    v_exp_f32 v197, v197
    v_permlane16_swap_b32 v251, v225
    v_add_f32 v250, v250, v224
    v_cvt_pk_bf16_f32 v194, v196, v197
    v_add_f32 v251, v251, v225
    v_mov_b32 v224, v250
    v_exp_f32 v198, v198
    v_mov_b32 v225, v251
    s_nop 1
    v_permlane32_swap_b32 v250, v224
    v_permlane32_swap_b32 v251, v225
    v_exp_f32 v199, v199
    v_add_f32 v250, v250, v224
    v_add_f32 v251, v251, v225
    v_cvt_pk_bf16_f32 v195, v198, v199
    v_cmp_nle_f32 s[42:43], v250, s40
    v_rcp_f32 v248, v250
    s_nop 0
    v_mov_b32 v249, v248
    v_mfma_f32_16x16x32_bf16 v[136:139], a[112:115], v[200:203], v[136:139]
    v_pk_mul_f32 v[8:9], v[8:9], v[248:249]
    v_pk_mul_f32 v[10:11], v[10:11], v[248:249]
    v_mfma_f32_16x16x32_bf16 v[140:143], a[116:119], v[200:203], v[140:143]
    v_pk_mul_f32 v[12:13], v[12:13], v[248:249]
    v_pk_mul_f32 v[14:15], v[14:15], v[248:249]
    v_mfma_f32_16x16x32_bf16 v[144:147], a[120:123], v[200:203], v[144:147]
    v_cvt_pk_bf16_f32 v168, v8, v9
    v_cvt_pk_bf16_f32 v169, v10, v11
    v_mfma_f32_16x16x32_bf16 v[148:151], a[124:127], v[200:203], v[148:151]
    v_cvt_pk_bf16_f32 v170, v12, v13
    v_cvt_pk_bf16_f32 v171, v14, v15
    v_mfma_f32_16x16x32_bf16 v[152:155], a[128:131], v[200:203], v[152:155]
    v_pk_fma_f32 v[246:247], v[8:9], 0, v[246:247]
    v_pk_fma_f32 v[246:247], v[10:11], 0, v[246:247]
    v_mfma_f32_16x16x32_bf16 v[156:159], a[132:135], v[200:203], v[156:159]
    v_permlane16_swap_b32 v168, v170
    v_permlane16_swap_b32 v169, v171
    v_mfma_f32_16x16x32_bf16 v[160:163], a[136:139], v[200:203], v[160:163]
    v_pk_fma_f32 v[246:247], v[12:13], 0, v[246:247]
    v_pk_fma_f32 v[246:247], v[14:15], 0, v[246:247]
    v_mfma_f32_16x16x32_bf16 v[164:167], a[140:143], v[200:203], v[164:167]
    ds_write_b128 v208, v[168:171] offset:0
    v_pk_mul_f32 v[16:17], v[16:17], v[248:249]
    v_mfma_f32_16x16x32_bf16 a[164:167], a[144:147], v[200:203], a[164:167]
    v_pk_mul_f32 v[18:19], v[18:19], v[248:249]
    v_pk_mul_f32 v[20:21], v[20:21], v[248:249]
    v_mfma_f32_16x16x32_bf16 v[72:75], a[112:115], v[184:187], v[72:75]
    v_pk_mul_f32 v[22:23], v[22:23], v[248:249]
    v_cvt_pk_bf16_f32 v172, v16, v17
    v_mfma_f32_16x16x32_bf16 v[104:107], a[112:115], v[192:195], v[104:107]
    v_cvt_pk_bf16_f32 v173, v18, v19
    v_cvt_pk_bf16_f32 v174, v20, v21
    v_mfma_f32_16x16x32_bf16 v[76:79], a[116:119], v[184:187], v[76:79]
    v_cvt_pk_bf16_f32 v175, v22, v23
    v_pk_fma_f32 v[246:247], v[16:17], 0, v[246:247]
    v_mfma_f32_16x16x32_bf16 v[108:111], a[116:119], v[192:195], v[108:111]
    v_pk_fma_f32 v[246:247], v[18:19], 0, v[246:247]
    v_permlane16_swap_b32 v172, v174
    v_mfma_f32_16x16x32_bf16 v[80:83], a[120:123], v[184:187], v[80:83]
    v_permlane16_swap_b32 v173, v175
    v_pk_fma_f32 v[246:247], v[20:21], 0, v[246:247]
    v_mfma_f32_16x16x32_bf16 v[112:115], a[120:123], v[192:195], v[112:115]
    v_pk_fma_f32 v[246:247], v[22:23], 0, v[246:247]
    ds_write_b128 v209, v[172:175] offset:0
    v_mfma_f32_16x16x32_bf16 v[84:87], a[124:127], v[184:187], v[84:87]
    v_pk_mul_f32 v[24:25], v[24:25], v[248:249]
    v_pk_mul_f32 v[26:27], v[26:27], v[248:249]
    v_mfma_f32_16x16x32_bf16 v[116:119], a[124:127], v[192:195], v[116:119]
    v_pk_mul_f32 v[28:29], v[28:29], v[248:249]
    v_pk_mul_f32 v[30:31], v[30:31], v[248:249]
    v_mfma_f32_16x16x32_bf16 v[88:91], a[128:131], v[184:187], v[88:91]
    v_cvt_pk_bf16_f32 v176, v24, v25
    v_cvt_pk_bf16_f32 v177, v26, v27
    v_mfma_f32_16x16x32_bf16 v[120:123], a[128:131], v[192:195], v[120:123]
    v_cvt_pk_bf16_f32 v178, v28, v29
    v_cvt_pk_bf16_f32 v179, v30, v31
    v_mfma_f32_16x16x32_bf16 v[92:95], a[132:135], v[184:187], v[92:95]
    v_pk_fma_f32 v[246:247], v[24:25], 0, v[246:247]
    v_pk_fma_f32 v[246:247], v[26:27], 0, v[246:247]
    v_mfma_f32_16x16x32_bf16 v[124:127], a[132:135], v[192:195], v[124:127]
    v_permlane16_swap_b32 v176, v178
    v_permlane16_swap_b32 v177, v179
    v_mfma_f32_16x16x32_bf16 v[96:99], a[136:139], v[184:187], v[96:99]
    v_pk_fma_f32 v[246:247], v[28:29], 0, v[246:247]
    v_pk_fma_f32 v[246:247], v[30:31], 0, v[246:247]
    v_mfma_f32_16x16x32_bf16 v[128:131], a[136:139], v[192:195], v[128:131]
    ds_write_b128 v210, v[176:179] offset:0
    v_pk_mul_f32 v[32:33], v[32:33], v[248:249]
    v_mfma_f32_16x16x32_bf16 v[100:103], a[140:143], v[184:187], v[100:103]
    v_pk_mul_f32 v[34:35], v[34:35], v[248:249]
    v_pk_mul_f32 v[36:37], v[36:37], v[248:249]
    v_mfma_f32_16x16x32_bf16 v[132:135], a[140:143], v[192:195], v[132:135]
    v_pk_mul_f32 v[38:39], v[38:39], v[248:249]
    v_cvt_pk_bf16_f32 v180, v32, v33
    v_mfma_f32_16x16x32_bf16 a[156:159], a[144:147], v[184:187], a[156:159]
    v_cvt_pk_bf16_f32 v181, v34, v35
    v_cvt_pk_bf16_f32 v182, v36, v37
    v_mfma_f32_16x16x32_bf16 a[160:163], a[144:147], v[192:195], a[160:163]
    v_cvt_pk_bf16_f32 v183, v38, v39
    v_pk_fma_f32 v[246:247], v[32:33], 0, v[246:247]
    v_pk_fma_f32 v[246:247], v[34:35], 0, v[246:247]
    v_permlane16_swap_b32 v180, v182
    v_permlane16_swap_b32 v181, v183
    v_pk_fma_f32 v[246:247], v[36:37], 0, v[246:247]
    v_pk_fma_f32 v[246:247], v[38:39], 0, v[246:247]
    ds_write_b128 v211, v[180:183] offset:0
    s_waitcnt lgkmcnt(0)
    ds_read_b128 v[8:11], v216 offset:0
    ds_read_b128 v[12:15], v216 offset:1024
    ds_read_b128 v[16:19], v216 offset:2048
    ds_read_b128 v[20:23], v216 offset:3072
    v_cmp_nle_f32 vcc, v251, s40
    v_rcp_f32 v248, v251
    s_or_b64 s[42:43], s[42:43], vcc
    v_mov_b32 v249, v248
    v_pk_mul_f32 v[40:41], v[40:41], v[248:249]
    v_pk_mul_f32 v[42:43], v[42:43], v[248:249]
    v_pk_mul_f32 v[44:45], v[44:45], v[248:249]
    v_pk_mul_f32 v[46:47], v[46:47], v[248:249]
    v_cvt_pk_bf16_f32 v168, v40, v41
    v_cvt_pk_bf16_f32 v169, v42, v43
    v_cvt_pk_bf16_f32 v170, v44, v45
    v_cvt_pk_bf16_f32 v171, v46, v47
    v_pk_fma_f32 v[246:247], v[40:41], 0, v[246:247]
    v_pk_fma_f32 v[246:247], v[42:43], 0, v[246:247]
    v_permlane16_swap_b32 v168, v170
    v_permlane16_swap_b32 v169, v171
    v_pk_fma_f32 v[246:247], v[44:45], 0, v[246:247]
    v_pk_fma_f32 v[246:247], v[46:47], 0, v[246:247]
    ds_write_b128 v208, v[168:171] offset:4096
    v_pk_mul_f32 v[48:49], v[48:49], v[248:249]
    v_pk_mul_f32 v[50:51], v[50:51], v[248:249]
    v_pk_mul_f32 v[52:53], v[52:53], v[248:249]
    v_pk_mul_f32 v[54:55], v[54:55], v[248:249]
    v_cvt_pk_bf16_f32 v172, v48, v49
    v_cvt_pk_bf16_f32 v173, v50, v51
    v_cvt_pk_bf16_f32 v174, v52, v53
    v_cvt_pk_bf16_f32 v175, v54, v55
    v_pk_fma_f32 v[246:247], v[48:49], 0, v[246:247]
    v_pk_fma_f32 v[246:247], v[50:51], 0, v[246:247]
    v_permlane16_swap_b32 v172, v174
    v_permlane16_swap_b32 v173, v175
    v_pk_fma_f32 v[246:247], v[52:53], 0, v[246:247]
    v_pk_fma_f32 v[246:247], v[54:55], 0, v[246:247]
    ds_write_b128 v209, v[172:175] offset:4096
    v_pk_mul_f32 v[56:57], v[56:57], v[248:249]
    v_pk_mul_f32 v[58:59], v[58:59], v[248:249]
    v_pk_mul_f32 v[60:61], v[60:61], v[248:249]
    v_pk_mul_f32 v[62:63], v[62:63], v[248:249]
    v_cvt_pk_bf16_f32 v176, v56, v57
    v_cvt_pk_bf16_f32 v177, v58, v59
    v_cvt_pk_bf16_f32 v178, v60, v61
    v_cvt_pk_bf16_f32 v179, v62, v63
    v_pk_fma_f32 v[246:247], v[56:57], 0, v[246:247]
    v_pk_fma_f32 v[246:247], v[58:59], 0, v[246:247]
    v_permlane16_swap_b32 v176, v178
    v_permlane16_swap_b32 v177, v179
    v_pk_fma_f32 v[246:247], v[60:61], 0, v[246:247]
    v_pk_fma_f32 v[246:247], v[62:63], 0, v[246:247]
    ds_write_b128 v210, v[176:179] offset:4096
    v_pk_mul_f32 v[64:65], v[64:65], v[248:249]
    v_pk_mul_f32 v[66:67], v[66:67], v[248:249]
    v_pk_mul_f32 v[68:69], v[68:69], v[248:249]
    v_pk_mul_f32 v[70:71], v[70:71], v[248:249]
    v_cvt_pk_bf16_f32 v180, v64, v65
    v_cvt_pk_bf16_f32 v181, v66, v67
    v_cvt_pk_bf16_f32 v182, v68, v69
    v_cvt_pk_bf16_f32 v183, v70, v71
    v_pk_fma_f32 v[246:247], v[64:65], 0, v[246:247]
    v_pk_fma_f32 v[246:247], v[66:67], 0, v[246:247]
    v_permlane16_swap_b32 v180, v182
    v_permlane16_swap_b32 v181, v183
    v_pk_fma_f32 v[246:247], v[68:69], 0, v[246:247]
    v_pk_fma_f32 v[246:247], v[70:71], 0, v[246:247]
    ds_write_b128 v211, v[180:183] offset:4096
    s_waitcnt lgkmcnt(4)
    buffer_store_dwordx4 v[8:11], v212, s[24:27], 0 offen sc1 nt
    buffer_store_dwordx4 v[12:15], v213, s[24:27], 0 offen sc1 nt
    buffer_store_dwordx4 v[16:19], v214, s[24:27], 0 offen sc1 nt
    buffer_store_dwordx4 v[20:23], v215, s[24:27], 0 offen sc1 nt
    v_accvgpr_read_b32 v244, a164
    ds_write_b128 v217, v[136:139] offset:0
    ds_write_b128 v217, v[140:143] offset:1024
    ds_write_b128 v217, v[144:147] offset:2048
    ds_write_b128 v217, v[148:151] offset:3072
    v_mov_b32 v136, v152
    v_mov_b32 v137, v153
    v_mov_b32 v138, v154
    v_mov_b32 v139, v155
    v_mov_b32 v140, v156
    v_mov_b32 v141, v157
    v_mov_b32 v142, v158
    v_mov_b32 v143, v159
    v_mov_b32 v144, v160
    v_mov_b32 v145, v161
    v_mov_b32 v146, v162
    v_mov_b32 v147, v163
    v_mov_b32 v148, v164
    v_mov_b32 v149, v165
    v_mov_b32 v150, v166
    v_mov_b32 v151, v167
L_epi:
    v_accvgpr_read_b32 v252, a156
    v_accvgpr_read_b32 v253, a160
    v_mul_u32_u24 v245, 12, v2
    v_sub_u32 v254, v217, v245
    v_sub_u32 v255, v218, v245
    v_mov_b32 v224, v244
    v_mov_b32 v225, v252
    v_mov_b32 v226, v253
    v_permlane16_swap_b32 v244, v224
    v_permlane16_swap_b32 v252, v225
    v_permlane16_swap_b32 v253, v226
    v_add_f32 v244, v244, v224
    v_add_f32 v252, v252, v225
    v_add_f32 v253, v253, v226
    v_mov_b32 v224, v244
    v_mov_b32 v225, v252
    v_mov_b32 v226, v253
    v_permlane32_swap_b32 v244, v224
    v_permlane32_swap_b32 v252, v225
    v_permlane32_swap_b32 v253, v226
    v_add_f32 v244, v244, v224
    v_add_f32 v252, v252, v225
    v_add_f32 v253, v253, v226
    ds_write_b32 v254, v244 offset:4096
    s_waitcnt lgkmcnt(0)
    s_barrier
    ds_read_b128 v[40:43], v216 offset:4096
    ds_read_b128 v[44:47], v216 offset:5120
    ds_read_b128 v[48:51], v216 offset:6144
    ds_read_b128 v[52:55], v216 offset:7168
    ds_read_b128 v[152:155], v218 offset:0
    ds_read_b128 v[156:159], v218 offset:1024
    ds_read_b128 v[160:163], v218 offset:2048
    ds_read_b128 v[164:167], v218 offset:3072
    ds_read_b32 v245, v255 offset:4096
    v_cmp_nle_f32 vcc, v252, s40
    v_rcp_f32 v248, v252
    s_or_b64 s[42:43], s[42:43], vcc
    v_mov_b32 v249, v248
    v_pk_mul_f32 v[72:73], v[72:73], v[248:249]
    v_pk_mul_f32 v[74:75], v[74:75], v[248:249]
    v_pk_mul_f32 v[76:77], v[76:77], v[248:249]
    v_pk_mul_f32 v[78:79], v[78:79], v[248:249]
    v_cvt_pk_bf16_f32 v168, v72, v73
    v_cvt_pk_bf16_f32 v169, v74, v75
    v_cvt_pk_bf16_f32 v170, v76, v77
    v_cvt_pk_bf16_f32 v171, v78, v79
    v_pk_fma_f32 v[246:247], v[72:73], 0, v[246:247]
    v_pk_fma_f32 v[246:247], v[74:75], 0, v[246:247]
    v_permlane16_swap_b32 v168, v170
    v_permlane16_swap_b32 v169, v171
    v_pk_fma_f32 v[246:247], v[76:77], 0, v[246:247]
    v_pk_fma_f32 v[246:247], v[78:79], 0, v[246:247]
    ds_write_b128 v208, v[168:171] offset:0
    v_pk_mul_f32 v[80:81], v[80:81], v[248:249]
    v_pk_mul_f32 v[82:83], v[82:83], v[248:249]
    v_pk_mul_f32 v[84:85], v[84:85], v[248:249]
    v_pk_mul_f32 v[86:87], v[86:87], v[248:249]
    v_cvt_pk_bf16_f32 v172, v80, v81
    v_cvt_pk_bf16_f32 v173, v82, v83
    v_cvt_pk_bf16_f32 v174, v84, v85
    v_cvt_pk_bf16_f32 v175, v86, v87
    v_pk_fma_f32 v[246:247], v[80:81], 0, v[246:247]
    v_pk_fma_f32 v[246:247], v[82:83], 0, v[246:247]
    v_permlane16_swap_b32 v172, v174
    v_permlane16_swap_b32 v173, v175
    v_pk_fma_f32 v[246:247], v[84:85], 0, v[246:247]
    v_pk_fma_f32 v[246:247], v[86:87], 0, v[246:247]
    ds_write_b128 v209, v[172:175] offset:0
    v_pk_mul_f32 v[88:89], v[88:89], v[248:249]
    v_pk_mul_f32 v[90:91], v[90:91], v[248:249]
    v_pk_mul_f32 v[92:93], v[92:93], v[248:249]
    v_pk_mul_f32 v[94:95], v[94:95], v[248:249]
    v_cvt_pk_bf16_f32 v176, v88, v89
    v_cvt_pk_bf16_f32 v177, v90, v91
    v_cvt_pk_bf16_f32 v178, v92, v93
    v_cvt_pk_bf16_f32 v179, v94, v95
    v_pk_fma_f32 v[246:247], v[88:89], 0, v[246:247]
    v_pk_fma_f32 v[246:247], v[90:91], 0, v[246:247]
    v_permlane16_swap_b32 v176, v178
    v_permlane16_swap_b32 v177, v179
    v_pk_fma_f32 v[246:247], v[92:93], 0, v[246:247]
    v_pk_fma_f32 v[246:247], v[94:95], 0, v[246:247]
    ds_write_b128 v210, v[176:179] offset:0
    v_pk_mul_f32 v[96:97], v[96:97], v[248:249]
    v_pk_mul_f32 v[98:99], v[98:99], v[248:249]
    v_pk_mul_f32 v[100:101], v[100:101], v[248:249]
    v_pk_mul_f32 v[102:103], v[102:103], v[248:249]
    v_cvt_pk_bf16_f32 v180, v96, v97
    v_cvt_pk_bf16_f32 v181, v98, v99
    v_cvt_pk_bf16_f32 v182, v100, v101
    v_cvt_pk_bf16_f32 v183, v102, v103
    v_pk_fma_f32 v[246:247], v[96:97], 0, v[246:247]
    v_pk_fma_f32 v[246:247], v[98:99], 0, v[246:247]
    v_permlane16_swap_b32 v180, v182
    v_permlane16_swap_b32 v181, v183
    v_pk_fma_f32 v[246:247], v[100:101], 0, v[246:247]
    v_pk_fma_f32 v[246:247], v[102:103], 0, v[246:247]
    ds_write_b128 v211, v[180:183] offset:0
    s_waitcnt lgkmcnt(4)
    buffer_store_dwordx4 v[40:43], v212, s[24:27], s38 offen sc1 nt
    buffer_store_dwordx4 v[44:47], v213, s[24:27], s38 offen sc1 nt
    buffer_store_dwordx4 v[48:51], v214, s[24:27], s38 offen sc1 nt
    buffer_store_dwordx4 v[52:55], v215, s[24:27], s38 offen sc1 nt
    s_waitcnt lgkmcnt(0)
    ds_read_b128 v[72:75], v216 offset:0
    ds_read_b128 v[76:79], v216 offset:1024
    ds_read_b128 v[80:83], v216 offset:2048
    ds_read_b128 v[84:87], v216 offset:3072
    v_cmp_nle_f32 vcc, v253, s40
    v_rcp_f32 v248, v253
    s_or_b64 s[42:43], s[42:43], vcc
    v_mov_b32 v249, v248
    v_pk_mul_f32 v[104:105], v[104:105], v[248:249]
    v_pk_mul_f32 v[106:107], v[106:107], v[248:249]
    v_pk_mul_f32 v[108:109], v[108:109], v[248:249]
    v_pk_mul_f32 v[110:111], v[110:111], v[248:249]
    v_cvt_pk_bf16_f32 v168, v104, v105
    v_cvt_pk_bf16_f32 v169, v106, v107
    v_cvt_pk_bf16_f32 v170, v108, v109
    v_cvt_pk_bf16_f32 v171, v110, v111
    v_pk_fma_f32 v[246:247], v[104:105], 0, v[246:247]
    v_pk_fma_f32 v[246:247], v[106:107], 0, v[246:247]
    v_permlane16_swap_b32 v168, v170
    v_permlane16_swap_b32 v169, v171
    v_pk_fma_f32 v[246:247], v[108:109], 0, v[246:247]
    v_pk_fma_f32 v[246:247], v[110:111], 0, v[246:247]
    ds_write_b128 v208, v[168:171] offset:4096
    v_pk_mul_f32 v[112:113], v[112:113], v[248:249]
    v_pk_mul_f32 v[114:115], v[114:115], v[248:249]
    v_pk_mul_f32 v[116:117], v[116:117], v[248:249]
    v_pk_mul_f32 v[118:119], v[118:119], v[248:249]
    v_cvt_pk_bf16_f32 v172, v112, v113
    v_cvt_pk_bf16_f32 v173, v114, v115
    v_cvt_pk_bf16_f32 v174, v116, v117
    v_cvt_pk_bf16_f32 v175, v118, v119
    v_pk_fma_f32 v[246:247], v[112:113], 0, v[246:247]
    v_pk_fma_f32 v[246:247], v[114:115], 0, v[246:247]
    v_permlane16_swap_b32 v172, v174
    v_permlane16_swap_b32 v173, v175
    v_pk_fma_f32 v[246:247], v[116:117], 0, v[246:247]
    v_pk_fma_f32 v[246:247], v[118:119], 0, v[246:247]
    ds_write_b128 v209, v[172:175] offset:4096
    v_pk_mul_f32 v[120:121], v[120:121], v[248:249]
    v_pk_mul_f32 v[122:123], v[122:123], v[248:249]
    v_pk_mul_f32 v[124:125], v[124:125], v[248:249]
    v_pk_mul_f32 v[126:127], v[126:127], v[248:249]
    v_cvt_pk_bf16_f32 v176, v120, v121
    v_cvt_pk_bf16_f32 v177, v122, v123
    v_cvt_pk_bf16_f32 v178, v124, v125
    v_cvt_pk_bf16_f32 v179, v126, v127
    v_pk_fma_f32 v[246:247], v[120:121], 0, v[246:247]
    v_pk_fma_f32 v[246:247], v[122:123], 0, v[246:247]
    v_permlane16_swap_b32 v176, v178
    v_permlane16_swap_b32 v177, v179
    v_pk_fma_f32 v[246:247], v[124:125], 0, v[246:247]
    v_pk_fma_f32 v[246:247], v[126:127], 0, v[246:247]
    ds_write_b128 v210, v[176:179] offset:4096
    v_pk_mul_f32 v[128:129], v[128:129], v[248:249]
    v_pk_mul_f32 v[130:131], v[130:131], v[248:249]
    v_pk_mul_f32 v[132:133], v[132:133], v[248:249]
    v_pk_mul_f32 v[134:135], v[134:135], v[248:249]
    v_cvt_pk_bf16_f32 v180, v128, v129
    v_cvt_pk_bf16_f32 v181, v130, v131
    v_cvt_pk_bf16_f32 v182, v132, v133
    v_cvt_pk_bf16_f32 v183, v134, v135
    v_pk_fma_f32 v[246:247], v[128:129], 0, v[246:247]
    v_pk_fma_f32 v[246:247], v[130:131], 0, v[246:247]
    v_permlane16_swap_b32 v180, v182
    v_permlane16_swap_b32 v181, v183
    v_pk_fma_f32 v[246:247], v[132:133], 0, v[246:247]
    v_pk_fma_f32 v[246:247], v[134:135], 0, v[246:247]
    ds_write_b128 v211, v[180:183] offset:4096
    s_waitcnt lgkmcnt(4)
    buffer_store_dwordx4 v[72:75], v212, s[24:27], s37 offen sc1 nt
    buffer_store_dwordx4 v[76:79], v213, s[24:27], s37 offen sc1 nt
    buffer_store_dwordx4 v[80:83], v214, s[24:27], s37 offen sc1 nt
    buffer_store_dwordx4 v[84:87], v215, s[24:27], s37 offen sc1 nt
    s_waitcnt lgkmcnt(0)
    ds_read_b128 v[104:107], v216 offset:4096
    ds_read_b128 v[108:111], v216 offset:5120
    ds_read_b128 v[112:115], v216 offset:6144
    ds_read_b128 v[116:119], v216 offset:7168
    v_pk_add_f32 v[136:137], v[136:137], v[152:153]
    v_pk_add_f32 v[138:139], v[138:139], v[154:155]
    v_pk_add_f32 v[140:141], v[140:141], v[156:157]
    v_pk_add_f32 v[142:143], v[142:143], v[158:159]
    v_pk_add_f32 v[144:145], v[144:145], v[160:161]
    v_pk_add_f32 v[146:147], v[146:147], v[162:163]
    v_pk_add_f32 v[148:149], v[148:149], v[164:165]
    v_pk_add_f32 v[150:151], v[150:151], v[166:167]
    v_add_f32 v244, v244, v245
    v_cmp_nle_f32 vcc, v244, s40
    v_rcp_f32 v248, v244
    s_or_b64 s[42:43], s[42:43], vcc
    v_mov_b32 v249, v248
    v_pk_mul_f32 v[136:137], v[136:137], v[248:249]
    v_pk_mul_f32 v[138:139], v[138:139], v[248:249]
    v_pk_mul_f32 v[140:141], v[140:141], v[248:249]
    v_pk_mul_f32 v[142:143], v[142:143], v[248:249]
    v_cvt_pk_bf16_f32 v168, v136, v137
    v_cvt_pk_bf16_f32 v169, v138, v139
    v_cvt_pk_bf16_f32 v170, v140, v141
    v_cvt_pk_bf16_f32 v171, v142, v143
    v_pk_fma_f32 v[246:247], v[136:137], 0, v[246:247]
    v_pk_fma_f32 v[246:247], v[138:139], 0, v[246:247]
    v_permlane16_swap_b32 v168, v170
    v_permlane16_swap_b32 v169, v171
    v_pk_fma_f32 v[246:247], v[140:141], 0, v[246:247]
    v_pk_fma_f32 v[246:247], v[142:143], 0, v[246:247]
    buffer_store_dwordx4 v[168:171], v219, s[24:27], 0 offen offset:0 sc1 nt
    v_pk_mul_f32 v[144:145], v[144:145], v[248:249]
    v_pk_mul_f32 v[146:147], v[146:147], v[248:249]
    v_pk_mul_f32 v[148:149], v[148:149], v[248:249]
    v_pk_mul_f32 v[150:151], v[150:151], v[248:249]
    v_cvt_pk_bf16_f32 v172, v144, v145
    v_cvt_pk_bf16_f32 v173, v146, v147
    v_cvt_pk_bf16_f32 v174, v148, v149
    v_cvt_pk_bf16_f32 v175, v150, v151
    v_pk_fma_f32 v[246:247], v[144:145], 0, v[246:247]
    v_pk_fma_f32 v[246:247], v[146:147], 0, v[246:247]
    v_permlane16_swap_b32 v172, v174
    v_permlane16_swap_b32 v173, v175
    v_pk_fma_f32 v[246:247], v[148:149], 0, v[246:247]
    v_pk_fma_f32 v[246:247], v[150:151], 0, v[246:247]
    buffer_store_dwordx4 v[172:175], v219, s[24:27], 0 offen offset:64 sc1 nt
    s_waitcnt lgkmcnt(0)
    buffer_store_dwordx4 v[104:107], v212, s[24:27], s47 offen sc1 nt
    buffer_store_dwordx4 v[108:111], v213, s[24:27], s47 offen sc1 nt
    buffer_store_dwordx4 v[112:115], v214, s[24:27], s47 offen sc1 nt
    buffer_store_dwordx4 v[116:119], v215, s[24:27], s47 offen sc1 nt
    v_cmp_u_f32 vcc, v246, v247
    s_cmp_lg_u32 s33, 0
    s_cbranch_scc1 L_end
    s_or_b64 s[42:43], s[42:43], vcc
    s_cmp_lg_u64 s[42:43], 0
    s_cselect_b32 s41, 1, 0
    s_lshl_b32 s44, s3, 2
    s_add_u32 s44, s44, 156672
    v_mov_b32 v168, s41
    v_mov_b32 v169, s44
    v_mov_b32 v170, 156672
    ds_write_b32 v169, v168
    s_waitcnt lgkmcnt(0)
    s_barrier
    ds_read_b128 v[172:175], v170
    s_waitcnt lgkmcnt(0)
    v_or3_b32 v168, v172, v173, v174
    v_or_b32 v168, v168, v175
    s_nop 0
    v_readfirstlane_b32 s41, v168
    s_nop 3
    s_cmp_eq_u32 s41, 0
    s_cbranch_scc1 L_end
    s_mov_b32 s33, 1
    s_waitcnt vmcnt(0)
    v_lshlrev_b32 v244, 8, v5
    v_lshl_add_u32 v244, v6, 4, v244
    v_mov_b32 v3, 0xff800000
    v_mov_b32 v4, 0xff800000
    v_mov_b32 v7, 0xff800000
    v_mov_b32 v252, 0xff800000
    v_mov_b32 v253, 0xff800000
    s_mov_b32 s45, 0
L_maxloop:
    s_add_u32 s46, s45, 4096
    buffer_load_dwordx4 a[80:83], v244, s[12:15], s45 offen offset:0
    buffer_load_dwordx4 a[84:87], v244, s[12:15], s45 offen offset:64
    buffer_load_dwordx4 a[88:91], v244, s[12:15], s45 offen offset:128
    buffer_load_dwordx4 a[92:95], v244, s[12:15], s45 offen offset:192
    buffer_load_dwordx4 a[96:99], v244, s[12:15], s46 offen offset:0
    buffer_load_dwordx4 a[100:103], v244, s[12:15], s46 offen offset:64
    buffer_load_dwordx4 a[104:107], v244, s[12:15], s46 offen offset:128
    buffer_load_dwordx4 a[108:111], v244, s[12:15], s46 offen offset:192
    s_waitcnt vmcnt(0)
    v_mfma_f32_16x16x32_bf16 v[168:171], a[80:83], a[0:3], 0
    v_mfma_f32_16x16x32_bf16 v[168:171], a[84:87], a[4:7], v[168:171]
    v_mfma_f32_16x16x32_bf16 v[168:171], a[88:91], a[8:11], v[168:171]
    v_mfma_f32_16x16x32_bf16 v[168:171], a[92:95], a[12:15], v[168:171]
    v_mfma_f32_16x16x32_bf16 v[172:175], a[96:99], a[0:3], 0
    v_mfma_f32_16x16x32_bf16 v[172:175], a[100:103], a[4:7], v[172:175]
    v_mfma_f32_16x16x32_bf16 v[172:175], a[104:107], a[8:11], v[172:175]
    v_mfma_f32_16x16x32_bf16 v[172:175], a[108:111], a[12:15], v[172:175]
    v_mfma_f32_16x16x32_bf16 v[176:179], a[80:83], a[16:19], 0
    v_mfma_f32_16x16x32_bf16 v[176:179], a[84:87], a[20:23], v[176:179]
    v_mfma_f32_16x16x32_bf16 v[176:179], a[88:91], a[24:27], v[176:179]
    v_mfma_f32_16x16x32_bf16 v[176:179], a[92:95], a[28:31], v[176:179]
    v_mfma_f32_16x16x32_bf16 v[180:183], a[96:99], a[16:19], 0
    v_mfma_f32_16x16x32_bf16 v[180:183], a[100:103], a[20:23], v[180:183]
    v_mfma_f32_16x16x32_bf16 v[180:183], a[104:107], a[24:27], v[180:183]
    v_mfma_f32_16x16x32_bf16 v[180:183], a[108:111], a[28:31], v[180:183]
    v_mfma_f32_16x16x32_bf16 v[184:187], a[80:83], a[32:35], 0
    v_mfma_f32_16x16x32_bf16 v[184:187], a[84:87], a[36:39], v[184:187]
    v_mfma_f32_16x16x32_bf16 v[184:187], a[88:91], a[40:43], v[184:187]
    v_mfma_f32_16x16x32_bf16 v[184:187], a[92:95], a[44:47], v[184:187]
    v_mfma_f32_16x16x32_bf16 v[188:191], a[96:99], a[32:35], 0
    v_mfma_f32_16x16x32_bf16 v[188:191], a[100:103], a[36:39], v[188:191]
    v_mfma_f32_16x16x32_bf16 v[188:191], a[104:107], a[40:43], v[188:191]
    v_mfma_f32_16x16x32_bf16 v[188:191], a[108:111], a[44:47], v[188:191]
    v_mfma_f32_16x16x32_bf16 v[192:195], a[80:83], a[48:51], 0
    v_mfma_f32_16x16x32_bf16 v[192:195], a[84:87], a[52:55], v[192:195]
    v_mfma_f32_16x16x32_bf16 v[192:195], a[88:91], a[56:59], v[192:195]
    v_mfma_f32_16x16x32_bf16 v[192:195], a[92:95], a[60:63], v[192:195]
    v_mfma_f32_16x16x32_bf16 v[196:199], a[96:99], a[48:51], 0
    v_mfma_f32_16x16x32_bf16 v[196:199], a[100:103], a[52:55], v[196:199]
    v_mfma_f32_16x16x32_bf16 v[196:199], a[104:107], a[56:59], v[196:199]
    v_mfma_f32_16x16x32_bf16 v[196:199], a[108:111], a[60:63], v[196:199]
    v_mfma_f32_16x16x32_bf16 v[200:203], a[80:83], a[64:67], 0
    v_mfma_f32_16x16x32_bf16 v[200:203], a[84:87], a[68:71], v[200:203]
    v_mfma_f32_16x16x32_bf16 v[200:203], a[88:91], a[72:75], v[200:203]
    v_mfma_f32_16x16x32_bf16 v[200:203], a[92:95], a[76:79], v[200:203]
    v_mfma_f32_16x16x32_bf16 v[204:207], a[96:99], a[64:67], 0
    v_mfma_f32_16x16x32_bf16 v[204:207], a[100:103], a[68:71], v[204:207]
    v_mfma_f32_16x16x32_bf16 v[204:207], a[104:107], a[72:75], v[204:207]
    v_mfma_f32_16x16x32_bf16 v[204:207], a[108:111], a[76:79], v[204:207]
    s_nop 7
    v_max3_f32 v3, v3, v168, v169
    v_max3_f32 v3, v3, v170, v171
    v_max3_f32 v3, v3, v172, v173
    v_max3_f32 v3, v3, v174, v175
    v_max3_f32 v4, v4, v176, v177
    v_max3_f32 v4, v4, v178, v179
    v_max3_f32 v4, v4, v180, v181
    v_max3_f32 v4, v4, v182, v183
    v_max3_f32 v7, v7, v184, v185
    v_max3_f32 v7, v7, v186, v187
    v_max3_f32 v7, v7, v188, v189
    v_max3_f32 v7, v7, v190, v191
    v_max3_f32 v252, v252, v192, v193
    v_max3_f32 v252, v252, v194, v195
    v_max3_f32 v252, v252, v196, v197
    v_max3_f32 v252, v252, v198, v199
    v_max3_f32 v253, v253, v200, v201
    v_max3_f32 v253, v253, v202, v203
    v_max3_f32 v253, v253, v204, v205
    v_max3_f32 v253, v253, v206, v207
    s_add_u32 s45, s45, 8192
    s_cmp_lt_u32 s45, 524288
    s_cbranch_scc1 L_maxloop
    s_barrier
    s_add_u32 m0, s30, 0
    s_mov_b32 s35, 0
    buffer_load_dwordx4 v240, s[12:15], s35 offen nt lds
    buffer_load_dwordx4 v241, s[12:15], s35 offen offset:1024 nt lds
    s_add_u32 m0, s30, 65536
    s_mov_b32 s35, 0
    buffer_load_dwordx4 v242, s[16:19], s35 offen nt lds
    buffer_load_dwordx4 v243, s[16:19], s35 offen offset:1024 nt lds
    s_add_u32 m0, s30, 8192
    s_mov_b32 s35, 8192
    buffer_load_dwordx4 v240, s[12:15], s35 offen nt lds
    buffer_load_dwordx4 v241, s[12:15], s35 offen offset:1024 nt lds
    s_add_u32 m0, s30, 73728
    s_mov_b32 s35, 8192
    buffer_load_dwordx4 v242, s[16:19], s35 offen nt lds
    buffer_load_dwordx4 v243, s[16:19], s35 offen offset:1024 nt lds
    s_add_u32 m0, s30, 16384
    s_mov_b32 s35, 16384
    buffer_load_dwordx4 v240, s[12:15], s35 offen nt lds
    buffer_load_dwordx4 v241, s[12:15], s35 offen offset:1024 nt lds
    s_add_u32 m0, s30, 81920
    s_mov_b32 s35, 16384
    buffer_load_dwordx4 v242, s[16:19], s35 offen nt lds
    buffer_load_dwordx4 v243, s[16:19], s35 offen offset:1024 nt lds
    s_add_u32 m0, s30, 24576
    s_mov_b32 s35, 24576
    buffer_load_dwordx4 v240, s[12:15], s35 offen nt lds
    buffer_load_dwordx4 v241, s[12:15], s35 offen offset:1024 nt lds
    s_add_u32 m0, s30, 90112
    s_mov_b32 s35, 24576
    buffer_load_dwordx4 v242, s[16:19], s35 offen nt lds
    buffer_load_dwordx4 v243, s[16:19], s35 offen offset:1024 nt lds
    s_add_u32 m0, s30, 32768
    s_mov_b32 s35, 32768
    buffer_load_dwordx4 v240, s[12:15], s35 offen nt lds
    buffer_load_dwordx4 v241, s[12:15], s35 offen offset:1024 nt lds
    s_mov_b32 s31, 32768
    s_mov_b32 s32, 40960
    v_accvgpr_write_b32 a112, 0
    v_accvgpr_write_b32 a113, 0
    v_accvgpr_write_b32 a114, 0
    v_accvgpr_write_b32 a115, 0
    v_accvgpr_write_b32 a116, 0
    v_accvgpr_write_b32 a117, 0
    v_accvgpr_write_b32 a118, 0
    v_accvgpr_write_b32 a119, 0
    v_accvgpr_write_b32 a120, 0
    v_accvgpr_write_b32 a121, 0
    v_accvgpr_write_b32 a122, 0
    v_accvgpr_write_b32 a123, 0
    v_accvgpr_write_b32 a124, 0
    v_accvgpr_write_b32 a125, 0
    v_accvgpr_write_b32 a126, 0
    v_accvgpr_write_b32 a127, 0
    v_accvgpr_write_b32 a128, 0
    v_accvgpr_write_b32 a129, 0
    v_accvgpr_write_b32 a130, 0
    v_accvgpr_write_b32 a131, 0
    v_accvgpr_write_b32 a132, 0
    v_accvgpr_write_b32 a133, 0
    v_accvgpr_write_b32 a134, 0
    v_accvgpr_write_b32 a135, 0
    v_accvgpr_write_b32 a136, 0
    v_accvgpr_write_b32 a137, 0
    v_accvgpr_write_b32 a138, 0
    v_accvgpr_write_b32 a139, 0
    v_accvgpr_write_b32 a140, 0
    v_accvgpr_write_b32 a141, 0
    v_accvgpr_write_b32 a142, 0
    v_accvgpr_write_b32 a143, 0
    v_accvgpr_write_b32 a148, 0
    v_accvgpr_write_b32 a149, 0
    v_accvgpr_write_b32 a150, 0
    v_accvgpr_write_b32 a151, 0
    v_accvgpr_write_b32 a152, 0
    v_accvgpr_write_b32 a153, 0
    v_accvgpr_write_b32 a154, 0
    v_accvgpr_write_b32 a155, 0
    v_accvgpr_write_b32 a156, 0
    v_accvgpr_write_b32 a157, 0
    v_accvgpr_write_b32 a158, 0
    v_accvgpr_write_b32 a159, 0
    v_accvgpr_write_b32 a160, 0
    v_accvgpr_write_b32 a161, 0
    v_accvgpr_write_b32 a162, 0
    v_accvgpr_write_b32 a163, 0
    v_accvgpr_write_b32 a164, 0
    v_accvgpr_write_b32 a165, 0
    v_accvgpr_write_b32 a166, 0
    v_accvgpr_write_b32 a167, 0
    v_mov_b32 v8, 0
    v_mov_b32 v9, 0
    v_mov_b32 v10, 0
    v_mov_b32 v11, 0
    v_mov_b32 v12, 0
    v_mov_b32 v13, 0
    v_mov_b32 v14, 0
    v_mov_b32 v15, 0
    v_mov_b32 v16, 0
    v_mov_b32 v17, 0
    v_mov_b32 v18, 0
    v_mov_b32 v19, 0
    v_mov_b32 v20, 0
    v_mov_b32 v21, 0
    v_mov_b32 v22, 0
    v_mov_b32 v23, 0
    v_mov_b32 v24, 0
    v_mov_b32 v25, 0
    v_mov_b32 v26, 0
    v_mov_b32 v27, 0
    v_mov_b32 v28, 0
    v_mov_b32 v29, 0
    v_mov_b32 v30, 0
    v_mov_b32 v31, 0
    v_mov_b32 v32, 0
    v_mov_b32 v33, 0
    v_mov_b32 v34, 0
    v_mov_b32 v35, 0
    v_mov_b32 v36, 0
    v_mov_b32 v37, 0
    v_mov_b32 v38, 0
    v_mov_b32 v39, 0
    v_mov_b32 v40, 0
    v_mov_b32 v41, 0
    v_mov_b32 v42, 0
    v_mov_b32 v43, 0
    v_mov_b32 v44, 0
    v_mov_b32 v45, 0
    v_mov_b32 v46, 0
    v_mov_b32 v47, 0
    v_mov_b32 v48, 0
    v_mov_b32 v49, 0
    v_mov_b32 v50, 0
    v_mov_b32 v51, 0
    v_mov_b32 v52, 0
    v_mov_b32 v53, 0
    v_mov_b32 v54, 0
    v_mov_b32 v55, 0
    v_mov_b32 v56, 0
    v_mov_b32 v57, 0
    v_mov_b32 v58, 0
    v_mov_b32 v59, 0
    v_mov_b32 v60, 0
    v_mov_b32 v61, 0
    v_mov_b32 v62, 0
    v_mov_b32 v63, 0
    v_mov_b32 v64, 0
    v_mov_b32 v65, 0
    v_mov_b32 v66, 0
    v_mov_b32 v67, 0
    v_mov_b32 v68, 0
    v_mov_b32 v69, 0
    v_mov_b32 v70, 0
    v_mov_b32 v71, 0
    v_mov_b32 v72, 0
    v_mov_b32 v73, 0
    v_mov_b32 v74, 0
    v_mov_b32 v75, 0
    v_mov_b32 v76, 0
    v_mov_b32 v77, 0
    v_mov_b32 v78, 0
    v_mov_b32 v79, 0
    v_mov_b32 v80, 0
    v_mov_b32 v81, 0
    v_mov_b32 v82, 0
    v_mov_b32 v83, 0
    v_mov_b32 v84, 0
    v_mov_b32 v85, 0
    v_mov_b32 v86, 0
    v_mov_b32 v87, 0
    v_mov_b32 v88, 0
    v_mov_b32 v89, 0
    v_mov_b32 v90, 0
    v_mov_b32 v91, 0
    v_mov_b32 v92, 0
    v_mov_b32 v93, 0
    v_mov_b32 v94, 0
    v_mov_b32 v95, 0
    v_mov_b32 v96, 0
    v_mov_b32 v97, 0
    v_mov_b32 v98, 0
    v_mov_b32 v99, 0
    v_mov_b32 v100, 0
    v_mov_b32 v101, 0
    v_mov_b32 v102, 0
    v_mov_b32 v103, 0
    v_mov_b32 v104, 0
    v_mov_b32 v105, 0
    v_mov_b32 v106, 0
    v_mov_b32 v107, 0
    v_mov_b32 v108, 0
    v_mov_b32 v109, 0
    v_mov_b32 v110, 0
    v_mov_b32 v111, 0
    v_mov_b32 v112, 0
    v_mov_b32 v113, 0
    v_mov_b32 v114, 0
    v_mov_b32 v115, 0
    v_mov_b32 v116, 0
    v_mov_b32 v117, 0
    v_mov_b32 v118, 0
    v_mov_b32 v119, 0
    v_mov_b32 v120, 0
    v_mov_b32 v121, 0
    v_mov_b32 v122, 0
    v_mov_b32 v123, 0
    v_mov_b32 v124, 0
    v_mov_b32 v125, 0
    v_mov_b32 v126, 0
    v_mov_b32 v127, 0
    v_mov_b32 v128, 0
    v_mov_b32 v129, 0
    v_mov_b32 v130, 0
    v_mov_b32 v131, 0
    v_mov_b32 v132, 0
    v_mov_b32 v133, 0
    v_mov_b32 v134, 0
    v_mov_b32 v135, 0
    v_mov_b32 v136, 0
    v_mov_b32 v137, 0
    v_mov_b32 v138, 0
    v_mov_b32 v139, 0
    v_mov_b32 v140, 0
    v_mov_b32 v141, 0
    v_mov_b32 v142, 0
    v_mov_b32 v143, 0
    v_mov_b32 v144, 0
    v_mov_b32 v145, 0
    v_mov_b32 v146, 0
    v_mov_b32 v147, 0
    v_mov_b32 v148, 0
    v_mov_b32 v149, 0
    v_mov_b32 v150, 0
    v_mov_b32 v151, 0
    v_mov_b32 v152, 0
    v_mov_b32 v153, 0
    v_mov_b32 v154, 0
    v_mov_b32 v155, 0
    v_mov_b32 v156, 0
    v_mov_b32 v157, 0
    v_mov_b32 v158, 0
    v_mov_b32 v159, 0
    v_mov_b32 v160, 0
    v_mov_b32 v161, 0
    v_mov_b32 v162, 0
    v_mov_b32 v163, 0
    v_mov_b32 v164, 0
    v_mov_b32 v165, 0
    v_mov_b32 v166, 0
    v_mov_b32 v167, 0
    s_waitcnt vmcnt(16)
    s_barrier
    ds_read_b128 a[80:83], v228 offset:0
    ds_read_b128 a[84:87], v229 offset:0
    ds_read_b128 a[88:91], v230 offset:0
    ds_read_b128 a[92:95], v231 offset:0
    ds_read_b128 a[96:99], v228 offset:4096
    ds_read_b128 a[100:103], v229 offset:4096
    ds_read_b128 a[104:107], v230 offset:4096
    ds_read_b128 a[108:111], v231 offset:4096
    v_mov_b32 v244, v3
    v_mov_b32 v245, v4
    v_mov_b32 v246, v7
    v_mov_b32 v247, v252
    v_mov_b32 v248, v253
    v_permlane16_swap_b32 v3, v244
    v_permlane16_swap_b32 v4, v245
    v_permlane16_swap_b32 v7, v246
    v_permlane16_swap_b32 v252, v247
    v_permlane16_swap_b32 v253, v248
    v_max_f32 v3, v3, v244
    v_max_f32 v4, v4, v245
    v_max_f32 v7, v7, v246
    v_max_f32 v252, v252, v247
    v_max_f32 v253, v253, v248
    v_mov_b32 v244, v3
    v_mov_b32 v245, v4
    v_mov_b32 v246, v7
    v_mov_b32 v247, v252
    v_mov_b32 v248, v253
    v_permlane32_swap_b32 v3, v244
    v_permlane32_swap_b32 v4, v245
    v_permlane32_swap_b32 v7, v246
    v_permlane32_swap_b32 v252, v247
    v_permlane32_swap_b32 v253, v248
    v_max_f32 v3, v3, v244
    v_max_f32 v4, v4, v245
    v_max_f32 v7, v7, v246
    v_max_f32 v252, v252, v247
    v_max_f32 v253, v253, v248
    v_sub_f32 v208, 0xc1300000, v3
    v_sub_f32 v209, 0xc1300000, v3
    v_sub_f32 v210, 0xc1300000, v3
    v_sub_f32 v211, 0xc1300000, v3
    v_sub_f32 v212, 0xc1300000, v4
    v_sub_f32 v213, 0xc1300000, v4
    v_sub_f32 v214, 0xc1300000, v4
    v_sub_f32 v215, 0xc1300000, v4
    v_sub_f32 v216, 0xc1300000, v7
    v_sub_f32 v217, 0xc1300000, v7
    v_sub_f32 v218, 0xc1300000, v7
    v_sub_f32 v219, 0xc1300000, v7
    v_sub_f32 v220, 0xc1300000, v252
    v_sub_f32 v221, 0xc1300000, v252
    v_sub_f32 v222, 0xc1300000, v252
    v_sub_f32 v223, 0xc1300000, v252
    v_sub_f32 v224, 0xc1300000, v253
    v_sub_f32 v225, 0xc1300000, v253
    v_sub_f32 v226, 0xc1300000, v253
    v_sub_f32 v227, 0xc1300000, v253
    v_mov_b32 v200, 0xf149f2ca
    v_mov_b32 v201, 0xf149f2ca
    v_mov_b32 v202, 0xf149f2ca
    v_mov_b32 v203, 0xf149f2ca
    v_mov_b32 v204, 0xf149f2ca
    v_mov_b32 v205, 0xf149f2ca
    v_mov_b32 v206, 0xf149f2ca
    v_mov_b32 v207, 0xf149f2ca
    s_mov_b32 s49, 65536
    v_mov_b32 v184, 0xf149f2ca
    v_mov_b32 v185, 0xf149f2ca
    v_mov_b32 v186, 0xf149f2ca
    v_mov_b32 v187, 0xf149f2ca
    v_mov_b32 v188, 0xf149f2ca
    v_mov_b32 v189, 0xf149f2ca
    v_mov_b32 v190, 0xf149f2ca
    v_mov_b32 v191, 0xf149f2ca
    v_mov_b32 v192, 0xf149f2ca
    v_mov_b32 v193, 0xf149f2ca
    v_mov_b32 v194, 0xf149f2ca
    v_mov_b32 v195, 0xf149f2ca
    v_mov_b32 v196, 0xf149f2ca
    v_mov_b32 v197, 0xf149f2ca
    v_mov_b32 v198, 0xf149f2ca
    v_mov_b32 v199, 0xf149f2ca
    s_waitcnt lgkmcnt(0)
    s_branch L_go
L_pf0_0_0:
    s_mov_b32 m0, s51
    s_nop 0
    buffer_load_dwordx4 v244, s[12:15], s49 offen lds
    buffer_load_dwordx4 v244, s[16:19], s49 offen lds
    s_add_u32 s49, s49, 4096
    s_branch L_pf0_0_0r
L_pf0_0_1:
    s_mov_b32 m0, s51
    s_nop 0
    buffer_load_dwordx4 v244, s[12:15], s49 offen lds
    buffer_load_dwordx4 v244, s[16:19], s49 offen lds
    s_add_u32 s49, s49, 4096
    s_branch L_pf0_0_1r
L_pf0_0_2:
    s_mov_b32 m0, s51
    s_nop 0
    buffer_load_dwordx4 v244, s[12:15], s49 offen lds
    buffer_load_dwordx4 v244, s[16:19], s49 offen lds
    s_add_u32 s49, s49, 4096
    s_branch L_pf0_0_2r
L_pf0_0_3:
    s_mov_b32 m0, s51
    s_nop 0
    buffer_load_dwordx4 v244, s[12:15], s49 offen lds
    buffer_load_dwordx4 v244, s[16:19], s49 offen lds
    s_add_u32 s49, s49, 4096
    s_branch L_pf0_0_3r
L_pf0_1_0:
    s_waitcnt vmcnt(14)
    s_barrier
    s_mov_b32 m0, s51
    s_nop 0
    buffer_load_dwordx4 v244, s[12:15], s49 offen lds
    buffer_load_dwordx4 v244, s[16:19], s49 offen lds
    s_add_u32 s49, s49, 4096
    s_branch L_pf0_1_0r
L_pf0_1_1:
    s_mov_b32 m0, s51
    s_nop 0
    buffer_load_dwordx4 v244, s[12:15], s49 offen lds
    buffer_load_dwordx4 v244, s[16:19], s49 offen lds
    s_add_u32 s49, s49, 4096
    s_branch L_pf0_1_1r
L_pf0_1_2:
    s_mov_b32 m0, s51
    s_nop 0
    buffer_load_dwordx4 v244, s[12:15], s49 offen lds
    buffer_load_dwordx4 v244, s[16:19], s49 offen lds
    s_add_u32 s49, s49, 4096
    s_branch L_pf0_1_2r
L_pf0_1_3:
    s_mov_b32 m0, s51
    s_nop 0
    buffer_load_dwordx4 v244, s[12:15], s49 offen lds
    buffer_load_dwordx4 v244, s[16:19], s49 offen lds
    s_add_u32 s49, s49, 4096
    s_branch L_pf0_1_3r
L_pf0_2_0:
    s_mov_b32 m0, s51
    s_nop 0
    buffer_load_dwordx4 v244, s[12:15], s49 offen lds
    buffer_load_dwordx4 v244, s[16:19], s49 offen lds
    s_add_u32 s49, s49, 4096
    s_branch L_pf0_2_0r
L_pf0_2_1:
    s_mov_b32 m0, s51
    s_nop 0
    buffer_load_dwordx4 v244, s[12:15], s49 offen lds
    buffer_load_dwordx4 v244, s[16:19], s49 offen lds
    s_add_u32 s49, s49, 4096
    s_branch L_pf0_2_1r
L_pf0_2_2:
    s_mov_b32 m0, s51
    s_nop 0
    buffer_load_dwordx4 v244, s[12:15], s49 offen lds
    buffer_load_dwordx4 v244, s[16:19], s49 offen lds
    s_add_u32 s49, s49, 4096
    s_branch L_pf0_2_2r
L_pf0_2_3:
    s_mov_b32 m0, s51
    s_nop 0
    buffer_load_dwordx4 v244, s[12:15], s49 offen lds
    buffer_load_dwordx4 v244, s[16:19], s49 offen lds
    s_add_u32 s49, s49, 4096
    s_branch L_pf0_2_3r
L_pf1_0_0:
    s_mov_b32 m0, s51
    s_nop 0
    buffer_load_dwordx4 v244, s[12:15], s49 offen lds
    buffer_load_dwordx4 v244, s[16:19], s49 offen lds
    s_add_u32 s49, s49, 4096
    s_branch L_pf1_0_0r
L_pf1_0_1:
    s_mov_b32 m0, s51
    s_nop 0
    buffer_load_dwordx4 v244, s[12:15], s49 offen lds
    buffer_load_dwordx4 v244, s[16:19], s49 offen lds
    s_add_u32 s49, s49, 4096
    s_branch L_pf1_0_1r
L_pf1_0_2:
    s_mov_b32 m0, s51
    s_nop 0
    buffer_load_dwordx4 v244, s[12:15], s49 offen lds
    buffer_load_dwordx4 v244, s[16:19], s49 offen lds
    s_add_u32 s49, s49, 4096
    s_branch L_pf1_0_2r
L_pf1_0_3:
    s_mov_b32 m0, s51
    s_nop 0
    buffer_load_dwordx4 v244, s[12:15], s49 offen lds
    buffer_load_dwordx4 v244, s[16:19], s49 offen lds
    s_add_u32 s49, s49, 4096
    s_branch L_pf1_0_3r
L_pf1_1_0:
    s_waitcnt vmcnt(14)
    s_barrier
    s_mov_b32 m0, s51
    s_nop 0
    buffer_load_dwordx4 v244, s[12:15], s49 offen lds
    buffer_load_dwordx4 v244, s[16:19], s49 offen lds
    s_add_u32 s49, s49, 4096
    s_branch L_pf1_1_0r
L_pf1_1_1:
    s_mov_b32 m0, s51
    s_nop 0
    buffer_load_dwordx4 v244, s[12:15], s49 offen lds
    buffer_load_dwordx4 v244, s[16:19], s49 offen lds
    s_add_u32 s49, s49, 4096
    s_branch L_pf1_1_1r
L_pf1_1_2:
    s_mov_b32 m0, s51
    s_nop 0
    buffer_load_dwordx4 v244, s[12:15], s49 offen lds
    buffer_load_dwordx4 v244, s[16:19], s49 offen lds
    s_add_u32 s49, s49, 4096
    s_branch L_pf1_1_2r
L_pf1_1_3:
    s_mov_b32 m0, s51
    s_nop 0
    buffer_load_dwordx4 v244, s[12:15], s49 offen lds
    buffer_load_dwordx4 v244, s[16:19], s49 offen lds
    s_add_u32 s49, s49, 4096
    s_branch L_pf1_1_3r
L_pf1_2_0:
    s_mov_b32 m0, s51
    s_nop 0
    buffer_load_dwordx4 v244, s[12:15], s49 offen lds
    buffer_load_dwordx4 v244, s[16:19], s49 offen lds
    s_add_u32 s49, s49, 4096
    s_branch L_pf1_2_0r
L_pf1_2_1:
    s_mov_b32 m0, s51
    s_nop 0
    buffer_load_dwordx4 v244, s[12:15], s49 offen lds
    buffer_load_dwordx4 v244, s[16:19], s49 offen lds
    s_add_u32 s49, s49, 4096
    s_branch L_pf1_2_1r
L_pf1_2_2:
    s_mov_b32 m0, s51
    s_nop 0
    buffer_load_dwordx4 v244, s[12:15], s49 offen lds
    buffer_load_dwordx4 v244, s[16:19], s49 offen lds
    s_add_u32 s49, s49, 4096
    s_branch L_pf1_2_2r
L_pf1_2_3:
    s_mov_b32 m0, s51
    s_nop 0
    buffer_load_dwordx4 v244, s[12:15], s49 offen lds
    buffer_load_dwordx4 v244, s[16:19], s49 offen lds
    s_add_u32 s49, s49, 4096
    s_branch L_pf1_2_3r
L_end:
    s_endpgm
.section .rodata,"a"
.p2align 6
.amdhsa_kernel standalone__mha_softmax__near_ridge_kernel
  .amdhsa_next_free_vgpr 440
  .amdhsa_next_free_sgpr 100
  .amdhsa_accum_offset 256
  .amdhsa_group_segment_fixed_size 0
  .amdhsa_kernarg_size 48
  .amdhsa_user_sgpr_count 2
  .amdhsa_user_sgpr_kernarg_segment_ptr 1
  .amdhsa_system_sgpr_workgroup_id_x 1
.end_amdhsa_kernel
```
